```python
import torch

def _softmax(x, axis=-1):
    return torch.softmax(x, dim=axis)
def _gelu(x):
    return torch.nn.functional.gelu(x, approximate="tanh")
def _silu(x):
    return torch.nn.functional.silu(x)
def _sigmoid(x):
    return torch.sigmoid(x)
def _layernorm(x, axis=-1, eps=1e-5):
    m = x.mean(dim=axis, keepdim=True)
    v = x.var(dim=axis, keepdim=True, unbiased=False)
    return (x - m) / torch.sqrt(v + eps)
def _scatter_add(tgt, idx, src, axis=0):
    return tgt.clone().index_add_(axis, idx, src)
def _segment_sum(src, seg, n):
    out = torch.zeros((n,) + src.shape[1:], dtype=src.dtype)
    return out.index_add_(0, seg, src)
def _pad(x, pw):
    flat = tuple(v for pair in reversed(pw) for v in pair)
    return torch.nn.functional.pad(x, flat)

kernel_name = 'standalone__geglu_ffn__prompt'

def setup_inputs():

    _w = (lambda a: (lambda t: t.to(torch.bfloat16) if t.is_floating_point() else t)(torch.as_tensor(a)))
    B, S, D, F = 1, 2048, 512, 1792
    return {
        "x": _w((lambda *s: torch.randn(*s, dtype=torch.bfloat16) * 0.05)(B, S, D)),
        "w_gate": _w((lambda *s: torch.randn(*s, dtype=torch.bfloat16) * 0.05)(D, F)),
        "w_up": _w((lambda *s: torch.randn(*s, dtype=torch.bfloat16) * 0.05)(D, F)),
        "w_down": _w((lambda *s: torch.randn(*s, dtype=torch.bfloat16) * 0.05)(F, D)),
    }

def reference(x, w_gate, w_up, w_down):
    return (_gelu(x @ w_gate) * (x @ w_up)) @ w_down
```

```asm
; @launch grid=(256,1,1) block=(512,1,1) lds=163840
.amdgcn_target "amdgcn-amd-amdhsa--gfx950"
.text
.globl standalone__geglu_ffn__prompt_kernel
.p2align 8
.type standalone__geglu_ffn__prompt_kernel,@function
standalone__geglu_ffn__prompt_kernel:
    s_load_dwordx8 s[4:11], s[0:1], 0
    s_load_dwordx4 s[24:27], s[0:1], 24
    s_load_dwordx4 s[28:31], s[0:1], 40
    s_cmp_ge_u32 s2, 224
    s_cbranch_scc0 L_reg0
    s_getpc_b64 s[52:53]
L_pc:
    s_bfe_u32 s35, s2, 0x20003
    v_lshlrev_b32 v232, 4, v0
    v_lshl_add_u32 v232, s35, 13, v232
    v_min_u32 v232, L_codeend-L_pc-16, v232
    v_mov_b32 v233, s53
    v_add_co_u32 v232, vcc, s52, v232
    s_nop 1
    v_addc_co_u32 v233, vcc, 0, v233, vcc
    global_load_dwordx4 v[204:207], v[232:233], off
L_reg0:
    v_lshrrev_b32 v1, 6, v0
    s_cmp_ge_u32 s2, 256
    s_cbranch_scc1 L_end
    v_readfirstlane_b32 s20, v1
    s_and_b32 s14, s2, 7
    s_lshr_b32 s15, s2, 3
    s_and_b32 s35, s15, 3
    s_lshr_b32 s19, s15, 2
    s_and_b32 s32, s14, 1
    s_lshl2_add_u32 s16, s32, s35
    s_lshr_b32 s84, s14, 1
    s_mul_i32 s17, s84, 7
    s_add_u32 s17, s17, s19
    s_lshl2_add_u32 s18, s14, s35
    s_and_b32 s21, s20, 3
    s_mov_b32 s34, s19
    s_cmp_eq_u32 s19, 3
    s_cselect_b32 s19, 7, s19
    s_cmp_eq_u32 s34, 7
    s_cselect_b32 s19, 3, s19
    s_cselect_b32 s34, 0, s34
    s_cbranch_scc1 L_spare
    v_and_b32 v235, 63, v0
    s_lshl1_add_u32 s36, s35, s32
    s_add_u32 s36, s36, s34
    s_sub_u32 s32, s36, 7
    s_min_u32 s36, s36, s32
    s_lshl_b32 s36, s36, 2
    s_mov_b32 s96, 0x07654210
    s_mov_b32 s97, 0x65421
    s_lshr_b64 s[96:97], s[96:97], s36
    s_and_b32 s36, s96, 0x0fffffff
    s_or_b32 s36, s36, 0x30000000
    s_lshl_b32 s39, s16, 18
    s_and_b32 s37, s21, 1
    s_lshl1_add_u32 s3, s84, s37
    s_and_b32 s3, s3, 7
    s_lshl_b32 s3, s3, 15
    s_add_u32 s3, s3, s39
    s_mul_i32 s37, s37, 114688
    s_lshl_b32 s32, s17, 7
    s_add_u32 s37, s37, s32
    s_and_b32 s22, s21, 2
    s_lshl_b32 s33, s21, 12
    s_cmp_lt_u32 s20, 4
    s_cselect_b32 s37, s3, s37
    s_cselect_b32 s38, 1, 1792
    s_cselect_b32 s12, 3, 1
    s_cselect_b32 s13, 0, 2
    s_cselect_b32 s23, 0, 0
    s_cselect_b32 s92, 64, 32
    s_cselect_b32 s93, 2, 7
    s_cselect_b32 s42, 8, 7
    s_cselect_b32 s94, 0, 0x10000
    s_cselect_b32 s95, s22, 0
    s_lshl_b32 s38, s38, 7
    s_lshl_b32 s93, s93, 9
    s_lshl_b32 s42, s42, 18
    v_lshrrev_b32 v232, 3, v235
    v_lshrrev_b32 v233, 4, v235
    v_and_b32 v233, s12, v233
    v_lshlrev_b32 v233, s13, v233
    v_or_b32 v233, s23, v233
    v_xor_b32 v233, v233, v235
    v_and_b32 v233, 7, v233
    v_mul_u32_u24 v232, s93, v232
    v_lshl_add_u32 v192, v233, 4, v232
    s_lshl_b32 s93, s93, 3
    s_sub_u32 s93, s93, 1024
    v_xor_b32 v193, s92, v192
    v_add_u32 v193, s93, v193
    s_lshl_b32 s93, s93, 1
    v_add_u32 v194, s93, v192
    v_add_u32 v195, s93, v193
    s_mov_b32 s43, 0x20000
    s_add_u32 s33, s33, s94
    s_lshl_b32 s95, s95, 1
    s_lshr_b32 s32, s36, s95
    s_and_b32 s32, s32, 7
    s_mul_i32 s32, s32, s38
    s_add_u32 s32, s32, s37
    s_mov_b32 m0, s33
    s_cmp_eq_u32 s22, 0
    s_waitcnt lgkmcnt(0)
    s_cselect_b32 s40, s6, s8
    s_cselect_b32 s41, s7, s9
    s_cmp_lt_u32 s20, 4
    s_cselect_b32 s40, s4, s40
    s_cselect_b32 s41, s5, s41
    buffer_load_dwordx4 v192, s[40:43], s32 offen offset:0 lds
    buffer_load_dwordx4 v193, s[40:43], s32 offen offset:1024 lds
    buffer_load_dwordx4 v194, s[40:43], s32 offen offset:2048 lds
    buffer_load_dwordx4 v195, s[40:43], s32 offen offset:3072 lds
    s_cbranch_scc0 L_B
.p2align 3
    s_lshl_b32 s33, s21, 12
    v_lshlrev_b32 v245, 4, v235
    s_lshr_b32 s23, s21, 1
    s_and_b32 s22, s21, 1
    s_add_u32 s34, s34, s14
    s_sub_u32 s32, s34, 7
    s_min_u32 s34, s34, s32
    s_bfe_u32 s32, s15, 0x10002
    s_lshl1_add_u32 s0, s84, s32
    s_add_u32 s0, s0, 6
    s_xor_b32 s1, s0, 1
    s_lshl2_add_u32 s32, s21, 0
    s_lshr_b32 s32, s36, s32
    s_and_b32 s32, s32, 7
    s_lshl_b32 s32, s32, 7
    s_add_u32 s93, s32, s39
    s_lshl2_add_u32 s32, s21, 16
    s_lshr_b32 s32, s36, s32
    s_and_b32 s32, s32, 7
    s_lshl_b32 s32, s32, 7
    s_add_u32 s94, s32, s39
    s_lshl_b32 s32, s23, 2
    s_lshr_b32 s87, s36, s32
    v_and_b32 v232, 15, v235
    v_bfe_u32 v233, v235, 1, 3
    v_lshrrev_b32 v234, 4, v235
    v_xor_b32 v233, v233, v234
    v_lshlrev_b32 v232, 7, v232
    v_lshl_add_u32 v240, v233, 4, v232
    v_xor_b32 v241, 64, v240
    v_lshlrev_b32 v232, 3, v234
    v_bfe_u32 v233, v235, 2, 2
    v_add_u32 v232, v232, v233
    v_lshlrev_b32 v232, 7, v232
    v_bfe_u32 v233, v235, 4, 1
    v_bfe_u32 v234, v235, 3, 1
    v_lshl_add_u32 v233, v234, 1, v233
    v_xor_b32 v233, s21, v233
    v_lshl_add_u32 v232, v233, 5, v232
    v_and_b32 v233, 3, v235
    v_lshl_add_u32 v232, v233, 3, v232
    v_add_u32 v244, 0x10000, v232
    s_add_u32 m0, s33, 16384
    s_bfe_u32 s32, s87, 0x30008
    s_lshl_b32 s32, s32, 7
    s_add_u32 s32, s32, s3
    buffer_load_dwordx4 v192, s[40:43], s32 offen offset:0 lds
    buffer_load_dwordx4 v193, s[40:43], s32 offen offset:1024 lds
    buffer_load_dwordx4 v194, s[40:43], s32 offen offset:2048 lds
    buffer_load_dwordx4 v195, s[40:43], s32 offen offset:3072 lds
    s_mov_b32 s32, 0xc0135761
    s_mov_b32 s12, 0xbdd2d3e8
    v_mov_b32 v246, s32
    s_lshl2_add_u32 s13, s17, s21
    s_mul_i32 s32, s16, 896
    s_add_u32 s13, s13, s32
    s_lshl1_add_u32 s76, s84, 0
    s_and_b32 s76, s76, 7
    s_mul_i32 s76, s76, 112
    s_add_u32 s76, s76, s13
    s_lshl_b32 s76, s76, 10
    s_lshl1_add_u32 s77, s84, 1
    s_and_b32 s77, s77, 7
    s_mul_i32 s77, s77, 112
    s_add_u32 s77, s77, s13
    s_lshl_b32 s77, s77, 10
    s_lshl1_add_u32 s78, s84, 2
    s_and_b32 s78, s78, 7
    s_mul_i32 s78, s78, 112
    s_add_u32 s78, s78, s13
    s_lshl_b32 s78, s78, 10
    s_lshl1_add_u32 s79, s84, 3
    s_and_b32 s79, s79, 7
    s_mul_i32 s79, s79, 112
    s_add_u32 s79, s79, s13
    s_lshl_b32 s79, s79, 10
    s_lshl1_add_u32 s80, s84, 4
    s_and_b32 s80, s80, 7
    s_mul_i32 s80, s80, 112
    s_add_u32 s80, s80, s13
    s_lshl_b32 s80, s80, 10
    s_lshl1_add_u32 s81, s84, 5
    s_and_b32 s81, s81, 7
    s_mul_i32 s81, s81, 112
    s_add_u32 s81, s81, s13
    s_lshl_b32 s81, s81, 10
    s_and_b32 s82, s0, 7
    s_mul_i32 s82, s82, 112
    s_add_u32 s82, s82, s13
    s_lshl_b32 s82, s82, 10
    s_and_b32 s83, s1, 7
    s_mul_i32 s83, s83, 112
    s_add_u32 s83, s83, s13
    s_lshl_b32 s83, s83, 10
    v_and_b32 v232, 15, v235
    s_lshl_b32 s32, s22, 1
    s_xor_b32 s32, s32, 2
    v_subrev_u32 v233, 10, v232
    v_xor_b32 v233, s32, v233
    v_add_u32 v233, 10, v233
    v_cmp_le_u32 vcc, 26, v235
    s_nop 1
    v_cndmask_b32 v232, v232, v233, vcc
    v_lshl_add_u32 v232, v232, 1, s23
    v_mul_u32_u24 v233, 37, v232
    v_lshrrev_b32 v233, 8, v233
    v_mul_u32_u24 v234, 7, v233
    v_sub_u32 v234, v232, v234
    v_add_u32 v234, s34, v234
    v_subrev_u32 v236, 7, v234
    v_min_u32 v236, v234, v236
    v_mul_u32_u24 v237, 86, v234
    v_lshrrev_b32 v237, 8, v237
    v_mul_u32_u24 v237, 3, v237
    v_sub_u32 v237, v234, v237
    v_lshl_add_u32 v237, v237, 1, 1
    v_cmp_le_u32 vcc, 21, v232
    v_and_b32 v234, 3, v234
    v_lshlrev_b32 v234, 1, v234
    v_cndmask_b32 v236, v236, v237, vcc
    v_cmp_le_u32 vcc, 24, v232
    v_sub_u32 v233, s35, v233
    v_and_b32 v233, 3, v233
    v_cndmask_b32 v236, v236, v234, vcc
    v_mad_u32_u24 v232, v233, 7, v236
    s_lshl_b32 s95, s19, 7
    s_lshl1_add_u32 s32, s18, s22
    s_mul_i32 s32, s32, 114688
    v_lshl_add_u32 v233, v232, 12, s32
    v_lshrrev_b32 v232, 5, v235
    v_readlane_b32 s60, v233, 16
    v_readlane_b32 s61, v233, 17
    v_readlane_b32 s62, v233, 18
    v_readlane_b32 s63, v233, 19
    v_readlane_b32 s64, v233, 20
    v_readlane_b32 s65, v233, 21
    v_readlane_b32 s66, v233, 22
    v_readlane_b32 s67, v233, 23
    v_readlane_b32 s68, v233, 24
    v_readlane_b32 s69, v233, 25
    v_readlane_b32 s70, v233, 26
    v_readlane_b32 s71, v233, 27
    v_readlane_b32 s72, v233, 28
    v_readlane_b32 s73, v233, 29
    v_lshrrev_b32 v232, 4, v235
    v_lshlrev_b32 v232, 3, v232
    v_bfe_u32 v233, v235, 2, 2
    v_add_u32 v232, v232, v233
    v_lshlrev_b32 v232, 7, v232
    v_bfe_u32 v233, v235, 3, 1
    v_lshl_add_u32 v232, v233, 6, v232
    v_bfe_u32 v233, v235, 4, 1
    v_lshl_add_u32 v232, v233, 5, v232
    v_and_b32 v233, 3, v235
    v_lshl_add_u32 v232, v233, 3, v232
    s_lshl_b32 s32, s23, 13
    s_add_u32 s32, s32, 49152
    v_add_u32 v178, s32, v232
    s_lshl_b32 s32, s23, 6
    v_xor_b32 v178, s32, v178
    v_xor_b32 v179, 32, v178
    v_xor_b32 v176, 64, v178
    v_xor_b32 v177, 64, v179
    v_lshrrev_b32 v232, 4, v235
    v_lshlrev_b32 v232, 9, v232
    v_and_b32 v233, 0xf0, v245
    v_add_u32 v180, v232, v233
    s_cmp_eq_u32 s22, 1
    s_cselect_b32 s88, 3, 5
    s_cselect_b32 s89, 1, 1
    s_cselect_b32 s90, 1, -3
    s_cselect_b32 s91, 1, 1
    s_lshl_b32 s88, s88, 14
    s_lshl_b32 s89, s89, 14
    s_lshl_b32 s90, s90, 14
    s_lshl_b32 s91, s91, 14
    s_mov_b32 s44, s26
    s_mov_b32 s45, s27
    s_mov_b32 s46, 0x200000
    s_mov_b32 s47, 0x20000
    v_and_b32 v232, 15, v235
    v_lshlrev_b32 v232, 10, v232
    v_lshrrev_b32 v233, 5, v235
    v_lshl_add_u32 v232, v233, 4, v232
    v_bfe_u32 v233, v235, 4, 1
    v_lshl_add_u32 v249, v233, 5, v232
    s_lshl_b32 s32, s18, 16
    s_add_u32 s95, s95, s32
    s_lshl_b32 s32, s22, 15
    s_add_u32 s95, s95, s32
    s_lshl_b32 s32, s23, 6
    s_add_u32 s95, s95, s32
    s_add_u32 s32, s33, 0
    v_add_u32 v250, s32, v245
    v_xor_b32 v251, 0x2000, v250
    s_mov_b32 s52, s30
    s_mov_b32 s53, s31
    s_mov_b32 s54, 7340032
    s_mov_b32 s55, 0x20000
    s_setprio 1
    s_waitcnt vmcnt(4)
    s_barrier
    ds_read_b64_tr_b16 v[0:1], v244 offset:0
    ds_read_b64_tr_b16 v[2:3], v244 offset:512
    ds_read_b128 v[208:211], v240 offset:0
    ds_read_b64_tr_b16 v[4:5], v244 offset:8192
    ds_read_b64_tr_b16 v[6:7], v244 offset:8704
    ds_read_b128 v[212:215], v240 offset:2048
    ds_read_b128 v[216:219], v240 offset:4096
    ds_read_b128 v[220:223], v240 offset:6144
    ds_read_b64_tr_b16 v[8:9], v244 offset:4096
    ds_read_b64_tr_b16 v[10:11], v244 offset:4608
    ds_read_b128 v[224:227], v241 offset:0
    ds_read_b64_tr_b16 v[12:13], v244 offset:12288
    ds_read_b64_tr_b16 v[14:15], v244 offset:12800
    ds_read_b128 v[228:231], v241 offset:2048
    s_waitcnt lgkmcnt(8)
    v_mfma_f32_16x16x32_bf16 v[128:131], v[0:3], v[208:211], 0
    v_mfma_f32_16x16x32_bf16 v[136:139], v[4:7], v[208:211], 0
    v_mfma_f32_16x16x32_bf16 v[132:135], v[0:3], v[212:215], 0
    ds_read_b128 v[208:211], v241 offset:4096
    v_mfma_f32_16x16x32_bf16 v[140:143], v[4:7], v[212:215], 0
    s_waitcnt lgkmcnt(7)
    v_mfma_f32_16x16x32_bf16 v[144:147], v[0:3], v[216:219], 0
    ds_read_b128 v[212:215], v241 offset:6144
    v_mfma_f32_16x16x32_bf16 v[152:155], v[4:7], v[216:219], 0
    v_mfma_f32_16x16x32_bf16 v[148:151], v[0:3], v[220:223], 0
    v_mfma_f32_16x16x32_bf16 v[156:159], v[4:7], v[220:223], 0
    s_waitcnt lgkmcnt(2)
    v_mfma_f32_16x16x32_bf16 v[128:131], v[8:11], v[224:227], v[128:131]
    v_mfma_f32_16x16x32_bf16 v[136:139], v[12:15], v[224:227], v[136:139]
    s_waitcnt lgkmcnt(0)
    s_barrier
    ds_read_b64_tr_b16 v[16:17], v244 offset:16384
    ds_read_b64_tr_b16 v[18:19], v244 offset:16896
    ds_read_b128 v[216:219], v240 offset:8192
    ds_read_b64_tr_b16 v[20:21], v244 offset:24576
    ds_read_b64_tr_b16 v[22:23], v244 offset:25088
    ds_read_b128 v[220:223], v240 offset:10240
    v_mfma_f32_16x16x32_bf16 v[132:135], v[8:11], v[228:231], v[132:135]
    ds_read_b128 v[224:227], v240 offset:12288
    v_mfma_f32_16x16x32_bf16 v[140:143], v[12:15], v[228:231], v[140:143]
    v_mfma_f32_16x16x32_bf16 v[144:147], v[8:11], v[208:211], v[144:147]
    ds_read_b128 v[228:231], v240 offset:14336
    v_mfma_f32_16x16x32_bf16 v[152:155], v[12:15], v[208:211], v[152:155]
    v_mfma_f32_16x16x32_bf16 v[148:151], v[8:11], v[212:215], v[148:151]
    ds_read_b64_tr_b16 v[24:25], v244 offset:20480
    ds_read_b64_tr_b16 v[26:27], v244 offset:20992
    ds_read_b128 v[208:211], v241 offset:8192
    ds_read_b64_tr_b16 v[28:29], v244 offset:28672
    ds_read_b64_tr_b16 v[30:31], v244 offset:29184
    v_mfma_f32_16x16x32_bf16 v[156:159], v[12:15], v[212:215], v[156:159]
    s_waitcnt lgkmcnt(7)
    v_mfma_f32_16x16x32_bf16 v[128:131], v[16:19], v[216:219], v[128:131]
    ds_read_b128 v[212:215], v241 offset:10240
    v_mfma_f32_16x16x32_bf16 v[136:139], v[20:23], v[216:219], v[136:139]
    v_mfma_f32_16x16x32_bf16 v[132:135], v[16:19], v[220:223], v[132:135]
    ds_read_b128 v[216:219], v241 offset:12288
    v_mfma_f32_16x16x32_bf16 v[140:143], v[20:23], v[220:223], v[140:143]
    s_waitcnt lgkmcnt(7)
    v_mfma_f32_16x16x32_bf16 v[144:147], v[16:19], v[224:227], v[144:147]
    ds_read_b128 v[220:223], v241 offset:14336
    v_mfma_f32_16x16x32_bf16 v[152:155], v[20:23], v[224:227], v[152:155]
    v_mfma_f32_16x16x32_bf16 v[148:151], v[16:19], v[228:231], v[148:151]
    v_mfma_f32_16x16x32_bf16 v[156:159], v[20:23], v[228:231], v[156:159]
    s_waitcnt lgkmcnt(2)
    v_mfma_f32_16x16x32_bf16 v[128:131], v[24:27], v[208:211], v[128:131]
    v_mfma_f32_16x16x32_bf16 v[136:139], v[28:31], v[208:211], v[136:139]
    s_waitcnt vmcnt(0) lgkmcnt(0)
    s_barrier
    ds_read_b64_tr_b16 v[32:33], v244 offset:32768
    ds_read_b64_tr_b16 v[34:35], v244 offset:33280
    ds_read_b128 v[224:227], v240 offset:16384
    ds_read_b64_tr_b16 v[36:37], v244 offset:40960
    ds_read_b64_tr_b16 v[38:39], v244 offset:41472
    ds_read_b128 v[228:231], v240 offset:18432
    v_mfma_f32_16x16x32_bf16 v[132:135], v[24:27], v[212:215], v[132:135]
    ds_read_b128 v[208:211], v240 offset:20480
    v_mfma_f32_16x16x32_bf16 v[140:143], v[28:31], v[212:215], v[140:143]
    v_mfma_f32_16x16x32_bf16 v[144:147], v[24:27], v[216:219], v[144:147]
    ds_read_b128 v[212:215], v240 offset:22528
    v_mfma_f32_16x16x32_bf16 v[152:155], v[28:31], v[216:219], v[152:155]
    v_mfma_f32_16x16x32_bf16 v[148:151], v[24:27], v[220:223], v[148:151]
    ds_read_b64_tr_b16 v[40:41], v244 offset:36864
    ds_read_b64_tr_b16 v[42:43], v244 offset:37376
    ds_read_b128 v[216:219], v241 offset:16384
    ds_read_b64_tr_b16 v[44:45], v244 offset:45056
    ds_read_b64_tr_b16 v[46:47], v244 offset:45568
    v_mfma_f32_16x16x32_bf16 v[156:159], v[28:31], v[220:223], v[156:159]
    s_waitcnt lgkmcnt(7)
    v_mfma_f32_16x16x32_bf16 v[128:131], v[32:35], v[224:227], v[128:131]
    ds_read_b128 v[220:223], v241 offset:18432
    v_mfma_f32_16x16x32_bf16 v[136:139], v[36:39], v[224:227], v[136:139]
    v_mfma_f32_16x16x32_bf16 v[132:135], v[32:35], v[228:231], v[132:135]
    ds_read_b128 v[224:227], v241 offset:20480
    v_mfma_f32_16x16x32_bf16 v[140:143], v[36:39], v[228:231], v[140:143]
    s_waitcnt lgkmcnt(7)
    v_mfma_f32_16x16x32_bf16 v[144:147], v[32:35], v[208:211], v[144:147]
    ds_read_b128 v[228:231], v241 offset:22528
    v_mfma_f32_16x16x32_bf16 v[152:155], v[36:39], v[208:211], v[152:155]
    v_mfma_f32_16x16x32_bf16 v[148:151], v[32:35], v[212:215], v[148:151]
    v_mfma_f32_16x16x32_bf16 v[156:159], v[36:39], v[212:215], v[156:159]
    s_waitcnt lgkmcnt(2)
    v_mfma_f32_16x16x32_bf16 v[128:131], v[40:43], v[216:219], v[128:131]
    v_mfma_f32_16x16x32_bf16 v[136:139], v[44:47], v[216:219], v[136:139]
    s_waitcnt lgkmcnt(0)
    s_barrier
    ds_read_b64_tr_b16 v[48:49], v244 offset:49152
    ds_read_b64_tr_b16 v[50:51], v244 offset:49664
    ds_read_b128 v[208:211], v240 offset:24576
    ds_read_b64_tr_b16 v[52:53], v244 offset:57344
    ds_read_b64_tr_b16 v[54:55], v244 offset:57856
    ds_read_b128 v[212:215], v240 offset:26624
    v_mfma_f32_16x16x32_bf16 v[132:135], v[40:43], v[220:223], v[132:135]
    ds_read_b128 v[216:219], v240 offset:28672
    v_mfma_f32_16x16x32_bf16 v[140:143], v[44:47], v[220:223], v[140:143]
    v_mfma_f32_16x16x32_bf16 v[144:147], v[40:43], v[224:227], v[144:147]
    ds_read_b128 v[220:223], v240 offset:30720
    v_mfma_f32_16x16x32_bf16 v[152:155], v[44:47], v[224:227], v[152:155]
    v_mfma_f32_16x16x32_bf16 v[148:151], v[40:43], v[228:231], v[148:151]
    ds_read_b64_tr_b16 v[56:57], v244 offset:53248
    ds_read_b64_tr_b16 v[58:59], v244 offset:53760
    ds_read_b128 v[224:227], v241 offset:24576
    ds_read_b64_tr_b16 v[60:61], v244 offset:61440
    ds_read_b64_tr_b16 v[62:63], v244 offset:61952
    v_mfma_f32_16x16x32_bf16 v[156:159], v[44:47], v[228:231], v[156:159]
    s_waitcnt lgkmcnt(7)
    v_mfma_f32_16x16x32_bf16 v[128:131], v[48:51], v[208:211], v[128:131]
    ds_read_b128 v[228:231], v241 offset:26624
    v_mfma_f32_16x16x32_bf16 v[136:139], v[52:55], v[208:211], v[136:139]
    v_mfma_f32_16x16x32_bf16 v[132:135], v[48:51], v[212:215], v[132:135]
    ds_read_b128 v[208:211], v241 offset:28672
    v_mfma_f32_16x16x32_bf16 v[140:143], v[52:55], v[212:215], v[140:143]
    s_waitcnt lgkmcnt(7)
    v_mfma_f32_16x16x32_bf16 v[144:147], v[48:51], v[216:219], v[144:147]
    ds_read_b128 v[212:215], v241 offset:30720
    v_mfma_f32_16x16x32_bf16 v[152:155], v[52:55], v[216:219], v[152:155]
    v_mfma_f32_16x16x32_bf16 v[148:151], v[48:51], v[220:223], v[148:151]
    v_mfma_f32_16x16x32_bf16 v[156:159], v[52:55], v[220:223], v[156:159]
    s_waitcnt lgkmcnt(2)
    v_mfma_f32_16x16x32_bf16 v[128:131], v[56:59], v[224:227], v[128:131]
    v_mfma_f32_16x16x32_bf16 v[136:139], v[60:63], v[224:227], v[136:139]
    s_waitcnt lgkmcnt(0)
    s_branch L_pg0
.p2align 12
L_stub0:
    s_setpc_b64 s[98:99]
L_pg0:
    s_barrier
    ds_read_b64_tr_b16 v[64:65], v244 offset:0
    ds_read_b64_tr_b16 v[66:67], v244 offset:512
    ds_read_b128 v[216:219], v240 offset:32768
    ds_read_b64_tr_b16 v[68:69], v244 offset:8192
    ds_read_b64_tr_b16 v[70:71], v244 offset:8704
    ds_read_b128 v[220:223], v240 offset:34816
    v_mfma_f32_16x16x32_bf16 v[132:135], v[56:59], v[228:231], v[132:135]
    ds_read_b128 v[224:227], v240 offset:36864
    v_mfma_f32_16x16x32_bf16 v[140:143], v[60:63], v[228:231], v[140:143]
    v_mfma_f32_16x16x32_bf16 v[144:147], v[56:59], v[208:211], v[144:147]
    ds_read_b128 v[228:231], v240 offset:38912
    v_mfma_f32_16x16x32_bf16 v[152:155], v[60:63], v[208:211], v[152:155]
    v_mfma_f32_16x16x32_bf16 v[148:151], v[56:59], v[212:215], v[148:151]
    ds_read_b64_tr_b16 v[72:73], v244 offset:4096
    ds_read_b64_tr_b16 v[74:75], v244 offset:4608
    ds_read_b128 v[208:211], v241 offset:32768
    ds_read_b64_tr_b16 v[76:77], v244 offset:12288
    ds_read_b64_tr_b16 v[78:79], v244 offset:12800
    v_mfma_f32_16x16x32_bf16 v[156:159], v[60:63], v[212:215], v[156:159]
    s_waitcnt lgkmcnt(7)
    v_mfma_f32_16x16x32_bf16 v[128:131], v[64:67], v[216:219], v[128:131]
    ds_read_b128 v[212:215], v241 offset:34816
    v_mfma_f32_16x16x32_bf16 v[136:139], v[68:71], v[216:219], v[136:139]
    v_mfma_f32_16x16x32_bf16 v[132:135], v[64:67], v[220:223], v[132:135]
    ds_read_b128 v[216:219], v241 offset:36864
    v_mfma_f32_16x16x32_bf16 v[140:143], v[68:71], v[220:223], v[140:143]
    s_waitcnt lgkmcnt(7)
    v_mfma_f32_16x16x32_bf16 v[144:147], v[64:67], v[224:227], v[144:147]
    ds_read_b128 v[220:223], v241 offset:38912
    v_mfma_f32_16x16x32_bf16 v[152:155], v[68:71], v[224:227], v[152:155]
    v_mfma_f32_16x16x32_bf16 v[148:151], v[64:67], v[228:231], v[148:151]
    v_mfma_f32_16x16x32_bf16 v[156:159], v[68:71], v[228:231], v[156:159]
    s_waitcnt lgkmcnt(2)
    v_mfma_f32_16x16x32_bf16 v[128:131], v[72:75], v[208:211], v[128:131]
    v_mfma_f32_16x16x32_bf16 v[136:139], v[76:79], v[208:211], v[136:139]
    s_waitcnt lgkmcnt(0)
    s_barrier
    ds_read_b64_tr_b16 v[80:81], v244 offset:16384
    ds_read_b64_tr_b16 v[82:83], v244 offset:16896
    ds_read_b128 v[224:227], v240 offset:40960
    ds_read_b64_tr_b16 v[84:85], v244 offset:24576
    ds_read_b64_tr_b16 v[86:87], v244 offset:25088
    ds_read_b128 v[228:231], v240 offset:43008
    v_mfma_f32_16x16x32_bf16 v[132:135], v[72:75], v[212:215], v[132:135]
    ds_read_b128 v[208:211], v240 offset:45056
    v_mfma_f32_16x16x32_bf16 v[140:143], v[76:79], v[212:215], v[140:143]
    v_mfma_f32_16x16x32_bf16 v[144:147], v[72:75], v[216:219], v[144:147]
    ds_read_b128 v[212:215], v240 offset:47104
    v_mfma_f32_16x16x32_bf16 v[152:155], v[76:79], v[216:219], v[152:155]
    v_mfma_f32_16x16x32_bf16 v[148:151], v[72:75], v[220:223], v[148:151]
    ds_read_b64_tr_b16 v[88:89], v244 offset:20480
    ds_read_b64_tr_b16 v[90:91], v244 offset:20992
    ds_read_b128 v[216:219], v241 offset:40960
    ds_read_b64_tr_b16 v[92:93], v244 offset:28672
    ds_read_b64_tr_b16 v[94:95], v244 offset:29184
    v_mfma_f32_16x16x32_bf16 v[156:159], v[76:79], v[220:223], v[156:159]
    s_waitcnt lgkmcnt(7)
    v_mfma_f32_16x16x32_bf16 v[128:131], v[80:83], v[224:227], v[128:131]
    ds_read_b128 v[220:223], v241 offset:43008
    v_mfma_f32_16x16x32_bf16 v[136:139], v[84:87], v[224:227], v[136:139]
    v_mfma_f32_16x16x32_bf16 v[132:135], v[80:83], v[228:231], v[132:135]
    ds_read_b128 v[224:227], v241 offset:45056
    v_mfma_f32_16x16x32_bf16 v[140:143], v[84:87], v[228:231], v[140:143]
    s_waitcnt lgkmcnt(7)
    v_mfma_f32_16x16x32_bf16 v[144:147], v[80:83], v[208:211], v[144:147]
    ds_read_b128 v[228:231], v241 offset:47104
    v_mfma_f32_16x16x32_bf16 v[152:155], v[84:87], v[208:211], v[152:155]
    v_mfma_f32_16x16x32_bf16 v[148:151], v[80:83], v[212:215], v[148:151]
    v_mfma_f32_16x16x32_bf16 v[156:159], v[84:87], v[212:215], v[156:159]
    s_waitcnt lgkmcnt(2)
    v_mfma_f32_16x16x32_bf16 v[128:131], v[88:91], v[216:219], v[128:131]
    v_mfma_f32_16x16x32_bf16 v[136:139], v[92:95], v[216:219], v[136:139]
    s_waitcnt lgkmcnt(0)
    s_barrier
    ds_read_b64_tr_b16 v[96:97], v244 offset:32768
    ds_read_b64_tr_b16 v[98:99], v244 offset:33280
    ds_read_b128 v[208:211], v240 offset:0
    ds_read_b64_tr_b16 v[100:101], v244 offset:40960
    ds_read_b64_tr_b16 v[102:103], v244 offset:41472
    ds_read_b128 v[212:215], v240 offset:2048
    v_mfma_f32_16x16x32_bf16 v[132:135], v[88:91], v[220:223], v[132:135]
    ds_read_b128 v[216:219], v240 offset:4096
    v_mfma_f32_16x16x32_bf16 v[140:143], v[92:95], v[220:223], v[140:143]
    v_mfma_f32_16x16x32_bf16 v[144:147], v[88:91], v[224:227], v[144:147]
    ds_read_b128 v[220:223], v240 offset:6144
    v_mfma_f32_16x16x32_bf16 v[152:155], v[92:95], v[224:227], v[152:155]
    v_mfma_f32_16x16x32_bf16 v[148:151], v[88:91], v[228:231], v[148:151]
    ds_read_b64_tr_b16 v[104:105], v244 offset:36864
    ds_read_b64_tr_b16 v[106:107], v244 offset:37376
    ds_read_b128 v[224:227], v241 offset:0
    ds_read_b64_tr_b16 v[108:109], v244 offset:45056
    ds_read_b64_tr_b16 v[110:111], v244 offset:45568
    v_mfma_f32_16x16x32_bf16 v[156:159], v[92:95], v[228:231], v[156:159]
    s_waitcnt lgkmcnt(7)
    v_mfma_f32_16x16x32_bf16 v[128:131], v[96:99], v[208:211], v[128:131]
    ds_read_b128 v[228:231], v241 offset:2048
    v_mfma_f32_16x16x32_bf16 v[136:139], v[100:103], v[208:211], v[136:139]
    v_mfma_f32_16x16x32_bf16 v[132:135], v[96:99], v[212:215], v[132:135]
    ds_read_b128 v[208:211], v241 offset:4096
    v_mfma_f32_16x16x32_bf16 v[140:143], v[100:103], v[212:215], v[140:143]
    s_waitcnt lgkmcnt(7)
    v_mfma_f32_16x16x32_bf16 v[144:147], v[96:99], v[216:219], v[144:147]
    ds_read_b128 v[212:215], v241 offset:6144
    v_mfma_f32_16x16x32_bf16 v[152:155], v[100:103], v[216:219], v[152:155]
    v_mfma_f32_16x16x32_bf16 v[148:151], v[96:99], v[220:223], v[148:151]
    v_mfma_f32_16x16x32_bf16 v[156:159], v[100:103], v[220:223], v[156:159]
    s_waitcnt lgkmcnt(2)
    v_mfma_f32_16x16x32_bf16 v[128:131], v[104:107], v[224:227], v[128:131]
    v_mfma_f32_16x16x32_bf16 v[136:139], v[108:111], v[224:227], v[136:139]
    s_waitcnt lgkmcnt(0)
    s_barrier
    ds_read_b64_tr_b16 v[112:113], v244 offset:49152
    ds_read_b64_tr_b16 v[114:115], v244 offset:49664
    ds_read_b128 v[216:219], v240 offset:8192
    ds_read_b64_tr_b16 v[116:117], v244 offset:57344
    ds_read_b64_tr_b16 v[118:119], v244 offset:57856
    ds_read_b128 v[220:223], v240 offset:10240
    v_mfma_f32_16x16x32_bf16 v[132:135], v[104:107], v[228:231], v[132:135]
    ds_read_b128 v[224:227], v240 offset:12288
    v_mfma_f32_16x16x32_bf16 v[140:143], v[108:111], v[228:231], v[140:143]
    v_mfma_f32_16x16x32_bf16 v[144:147], v[104:107], v[208:211], v[144:147]
    ds_read_b128 v[228:231], v240 offset:14336
    v_mfma_f32_16x16x32_bf16 v[152:155], v[108:111], v[208:211], v[152:155]
    v_mfma_f32_16x16x32_bf16 v[148:151], v[104:107], v[212:215], v[148:151]
    ds_read_b64_tr_b16 v[120:121], v244 offset:53248
    ds_read_b64_tr_b16 v[122:123], v244 offset:53760
    ds_read_b128 v[208:211], v241 offset:8192
    ds_read_b64_tr_b16 v[124:125], v244 offset:61440
    ds_read_b64_tr_b16 v[126:127], v244 offset:61952
    v_mfma_f32_16x16x32_bf16 v[156:159], v[108:111], v[212:215], v[156:159]
    s_waitcnt lgkmcnt(7)
    v_mfma_f32_16x16x32_bf16 v[128:131], v[112:115], v[216:219], v[128:131]
    ds_read_b128 v[212:215], v241 offset:10240
    v_mfma_f32_16x16x32_bf16 v[136:139], v[116:119], v[216:219], v[136:139]
    v_mfma_f32_16x16x32_bf16 v[132:135], v[112:115], v[220:223], v[132:135]
    ds_read_b128 v[216:219], v241 offset:12288
    v_mfma_f32_16x16x32_bf16 v[140:143], v[116:119], v[220:223], v[140:143]
    s_waitcnt lgkmcnt(7)
    v_mfma_f32_16x16x32_bf16 v[144:147], v[112:115], v[224:227], v[144:147]
    ds_read_b128 v[220:223], v241 offset:14336
    v_mfma_f32_16x16x32_bf16 v[152:155], v[116:119], v[224:227], v[152:155]
    v_mfma_f32_16x16x32_bf16 v[148:151], v[112:115], v[228:231], v[148:151]
    v_mfma_f32_16x16x32_bf16 v[156:159], v[116:119], v[228:231], v[156:159]
    s_waitcnt lgkmcnt(2)
    v_mfma_f32_16x16x32_bf16 v[128:131], v[120:123], v[208:211], v[128:131]
    v_mfma_f32_16x16x32_bf16 v[136:139], v[124:127], v[208:211], v[136:139]
    s_waitcnt lgkmcnt(0)
    s_barrier
    ds_read_b128 v[224:227], v240 offset:16384
    ds_read_b128 v[228:231], v240 offset:18432
    v_mfma_f32_16x16x32_bf16 v[132:135], v[120:123], v[212:215], v[132:135]
    ds_read_b128 v[208:211], v241 offset:16384
    v_mfma_f32_16x16x32_bf16 v[140:143], v[124:127], v[212:215], v[140:143]
    v_mfma_f32_16x16x32_bf16 v[144:147], v[120:123], v[216:219], v[144:147]
    ds_read_b128 v[212:215], v241 offset:18432
    v_mfma_f32_16x16x32_bf16 v[152:155], v[124:127], v[216:219], v[152:155]
    v_mfma_f32_16x16x32_bf16 v[148:151], v[120:123], v[220:223], v[148:151]
    ds_read_b128 v[216:219], v240 offset:20480
    v_mfma_f32_16x16x32_bf16 v[156:159], v[124:127], v[220:223], v[156:159]
    s_waitcnt lgkmcnt(3)
    v_mfma_f32_16x16x32_bf16 v[160:163], v[0:3], v[224:227], 0
    ds_read_b128 v[220:223], v240 offset:22528
    v_mfma_f32_16x16x32_bf16 v[168:171], v[4:7], v[224:227], 0
    v_mfma_f32_16x16x32_bf16 v[164:167], v[0:3], v[228:231], 0
    ds_read_b128 v[224:227], v241 offset:20480
    v_mfma_f32_16x16x32_bf16 v[172:175], v[4:7], v[228:231], 0
    v_mul_f32 v232, v128, v128
    v_fma_f32 v232, v232, s12, v246
    s_waitcnt lgkmcnt(3)
    v_mfma_f32_16x16x32_bf16 v[160:163], v[8:11], v[208:211], v[160:163]
    ds_read_b128 v[228:231], v241 offset:22528
    v_mul_f32 v232, v232, v128
    v_mul_f32 v233, v129, v129
    v_mfma_f32_16x16x32_bf16 v[168:171], v[12:15], v[208:211], v[168:171]
    v_exp_f32 v232, v232
    v_mfma_f32_16x16x32_bf16 v[164:167], v[8:11], v[212:215], v[164:167]
    ds_read_b128 v[208:211], v240 offset:24576
    v_fma_f32 v233, v233, s12, v246
    v_mul_f32 v136, v128, v136
    v_mfma_f32_16x16x32_bf16 v[172:175], v[12:15], v[212:215], v[172:175]
    v_mul_f32 v233, v233, v129
    v_mul_f32 v234, v130, v130
    s_waitcnt lgkmcnt(3)
    v_mfma_f32_16x16x32_bf16 v[160:163], v[16:19], v[216:219], v[160:163]
    ds_read_b128 v[212:215], v240 offset:26624
    v_add_f32 v232, 1.0, v232
    v_exp_f32 v233, v233
    v_mfma_f32_16x16x32_bf16 v[168:171], v[20:23], v[216:219], v[168:171]
    v_fma_f32 v234, v234, s12, v246
    v_mfma_f32_16x16x32_bf16 v[164:167], v[16:19], v[220:223], v[164:167]
    ds_read_b128 v[216:219], v241 offset:24576
    v_rcp_f32 v232, v232
    v_mfma_f32_16x16x32_bf16 v[172:175], v[20:23], v[220:223], v[172:175]
    v_mul_f32 v137, v129, v137
    v_mul_f32 v234, v234, v130
    s_waitcnt lgkmcnt(3)
    v_mfma_f32_16x16x32_bf16 v[160:163], v[24:27], v[224:227], v[160:163]
    ds_read_b128 v[220:223], v241 offset:26624
    v_mul_f32 v235, v131, v131
    v_mul_f32 v136, v136, v232
    v_mfma_f32_16x16x32_bf16 v[168:171], v[28:31], v[224:227], v[168:171]
    v_add_f32 v233, 1.0, v233
    v_exp_f32 v234, v234
    v_mfma_f32_16x16x32_bf16 v[164:167], v[24:27], v[228:231], v[164:167]
    ds_read_b128 v[224:227], v240 offset:28672
    v_fma_f32 v235, v235, s12, v246
    v_mfma_f32_16x16x32_bf16 v[172:175], v[28:31], v[228:231], v[172:175]
    v_rcp_f32 v233, v233
    s_waitcnt lgkmcnt(3)
    v_mfma_f32_16x16x32_bf16 v[160:163], v[32:35], v[208:211], v[160:163]
    ds_read_b128 v[228:231], v240 offset:30720
    v_mul_f32 v138, v130, v138
    v_mul_f32 v235, v235, v131
    v_mfma_f32_16x16x32_bf16 v[168:171], v[36:39], v[208:211], v[168:171]
    v_mul_f32 v236, v132, v132
    v_mul_f32 v137, v137, v233
    v_mfma_f32_16x16x32_bf16 v[164:167], v[32:35], v[212:215], v[164:167]
    ds_read_b128 v[208:211], v241 offset:28672
    v_add_f32 v234, 1.0, v234
    v_exp_f32 v235, v235
    v_mfma_f32_16x16x32_bf16 v[172:175], v[36:39], v[212:215], v[172:175]
    v_fma_f32 v236, v236, s12, v246
    s_waitcnt lgkmcnt(3)
    v_mfma_f32_16x16x32_bf16 v[160:163], v[40:43], v[216:219], v[160:163]
    ds_read_b128 v[212:215], v241 offset:30720
    v_rcp_f32 v234, v234
    v_mfma_f32_16x16x32_bf16 v[168:171], v[44:47], v[216:219], v[168:171]
    v_mul_f32 v139, v131, v139
    v_mul_f32 v236, v236, v132
    v_mfma_f32_16x16x32_bf16 v[164:167], v[40:43], v[220:223], v[164:167]
    v_mul_f32 v237, v133, v133
    v_cvt_pk_bf16_f32 v128, v136, v137
    v_mfma_f32_16x16x32_bf16 v[172:175], v[44:47], v[220:223], v[172:175]
    v_mul_f32 v138, v138, v234
    v_add_f32 v235, 1.0, v235
    s_waitcnt lgkmcnt(2)
    v_mfma_f32_16x16x32_bf16 v[160:163], v[48:51], v[224:227], v[160:163]
    v_exp_f32 v236, v236
    v_mfma_f32_16x16x32_bf16 v[168:171], v[52:55], v[224:227], v[168:171]
    v_fma_f32 v237, v237, s12, v246
    v_rcp_f32 v235, v235
    s_waitcnt lgkmcnt(0)
    s_barrier
    ds_read_b128 v[216:219], v240 offset:32768
    ds_read_b128 v[220:223], v240 offset:34816
    v_mfma_f32_16x16x32_bf16 v[164:167], v[48:51], v[228:231], v[164:167]
    ds_read_b128 v[224:227], v241 offset:32768
    v_mul_f32 v140, v132, v140
    v_mfma_f32_16x16x32_bf16 v[172:175], v[52:55], v[228:231], v[172:175]
    v_mul_f32 v237, v237, v133
    v_mul_f32 v238, v134, v134
    v_mfma_f32_16x16x32_bf16 v[160:163], v[56:59], v[208:211], v[160:163]
    ds_read_b128 v[228:231], v241 offset:34816
    v_mul_f32 v139, v139, v235
    v_add_f32 v236, 1.0, v236
    v_mfma_f32_16x16x32_bf16 v[168:171], v[60:63], v[208:211], v[168:171]
    v_exp_f32 v237, v237
    v_mfma_f32_16x16x32_bf16 v[164:167], v[56:59], v[212:215], v[164:167]
    ds_read_b128 v[208:211], v240 offset:36864
    v_fma_f32 v238, v238, s12, v246
    v_rcp_f32 v236, v236
    v_mfma_f32_16x16x32_bf16 v[172:175], v[60:63], v[212:215], v[172:175]
    v_mul_f32 v141, v133, v141
    s_waitcnt lgkmcnt(3)
    v_mfma_f32_16x16x32_bf16 v[160:163], v[64:67], v[216:219], v[160:163]
    ds_read_b128 v[212:215], v240 offset:38912
    v_mul_f32 v238, v238, v134
    v_mul_f32 v239, v135, v135
    v_mfma_f32_16x16x32_bf16 v[168:171], v[68:71], v[216:219], v[168:171]
    v_cvt_pk_bf16_f32 v129, v138, v139
    v_mul_f32 v140, v140, v236
    v_mfma_f32_16x16x32_bf16 v[164:167], v[64:67], v[220:223], v[164:167]
    ds_read_b128 v[216:219], v241 offset:36864
    v_add_f32 v237, 1.0, v237
    v_exp_f32 v238, v238
    v_mfma_f32_16x16x32_bf16 v[172:175], v[68:71], v[220:223], v[172:175]
    v_fma_f32 v239, v239, s12, v246
    s_waitcnt lgkmcnt(3)
    v_mfma_f32_16x16x32_bf16 v[160:163], v[72:75], v[224:227], v[160:163]
    ds_read_b128 v[220:223], v241 offset:38912
    v_rcp_f32 v237, v237
    v_mfma_f32_16x16x32_bf16 v[168:171], v[76:79], v[224:227], v[168:171]
    v_mul_f32 v142, v134, v142
    v_mul_f32 v239, v239, v135
    v_mfma_f32_16x16x32_bf16 v[164:167], v[72:75], v[228:231], v[164:167]
    ds_read_b128 v[224:227], v240 offset:40960
    v_mul_f32 v141, v141, v237
    v_add_f32 v238, 1.0, v238
    v_mfma_f32_16x16x32_bf16 v[172:175], v[76:79], v[228:231], v[172:175]
    v_exp_f32 v239, v239
    s_waitcnt lgkmcnt(3)
    v_mfma_f32_16x16x32_bf16 v[160:163], v[80:83], v[208:211], v[160:163]
    ds_read_b128 v[228:231], v240 offset:43008
    v_rcp_f32 v238, v238
    v_mfma_f32_16x16x32_bf16 v[168:171], v[84:87], v[208:211], v[168:171]
    v_mul_f32 v143, v135, v143
    v_cvt_pk_bf16_f32 v130, v140, v141
    v_mfma_f32_16x16x32_bf16 v[164:167], v[80:83], v[212:215], v[164:167]
    ds_read_b128 v[208:211], v241 offset:40960
    v_mul_f32 v142, v142, v238
    v_add_f32 v239, 1.0, v239
    v_mfma_f32_16x16x32_bf16 v[172:175], v[84:87], v[212:215], v[172:175]
    v_rcp_f32 v239, v239
    s_waitcnt lgkmcnt(3)
    v_mfma_f32_16x16x32_bf16 v[160:163], v[88:91], v[216:219], v[160:163]
    ds_read_b128 v[212:215], v241 offset:43008
    v_mul_f32 v143, v143, v239
    v_cvt_pk_bf16_f32 v131, v142, v143
    v_mfma_f32_16x16x32_bf16 v[168:171], v[92:95], v[216:219], v[168:171]
    v_permlane16_swap_b32 v128, v130
    v_permlane16_swap_b32 v129, v131
    v_mfma_f32_16x16x32_bf16 v[164:167], v[88:91], v[220:223], v[164:167]
    ds_read_b128 v[216:219], v240 offset:45056
    buffer_store_dwordx4 v[128:131], v245, s[52:55], s76 offen sc1
    v_mul_f32 v232, v144, v144
    v_mfma_f32_16x16x32_bf16 v[172:175], v[92:95], v[220:223], v[172:175]
    v_fma_f32 v232, v232, s12, v246
    v_mul_f32 v232, v232, v144
    s_waitcnt lgkmcnt(3)
    v_mfma_f32_16x16x32_bf16 v[160:163], v[96:99], v[224:227], v[160:163]
    ds_read_b128 v[220:223], v240 offset:47104
    v_mul_f32 v233, v145, v145
    v_exp_f32 v232, v232
    v_mfma_f32_16x16x32_bf16 v[168:171], v[100:103], v[224:227], v[168:171]
    v_fma_f32 v233, v233, s12, v246
    v_mfma_f32_16x16x32_bf16 v[164:167], v[96:99], v[228:231], v[164:167]
    ds_read_b128 v[224:227], v241 offset:45056
    v_mul_f32 v152, v144, v152
    v_mul_f32 v233, v233, v145
    v_mfma_f32_16x16x32_bf16 v[172:175], v[100:103], v[228:231], v[172:175]
    v_mul_f32 v234, v146, v146
    v_add_f32 v232, 1.0, v232
    s_waitcnt lgkmcnt(3)
    v_mfma_f32_16x16x32_bf16 v[160:163], v[104:107], v[208:211], v[160:163]
    ds_read_b128 v[228:231], v241 offset:47104
    v_exp_f32 v233, v233
    v_mfma_f32_16x16x32_bf16 v[168:171], v[108:111], v[208:211], v[168:171]
    v_fma_f32 v234, v234, s12, v246
    v_rcp_f32 v232, v232
    v_mfma_f32_16x16x32_bf16 v[164:167], v[104:107], v[212:215], v[164:167]
    v_mul_f32 v153, v145, v153
    v_mfma_f32_16x16x32_bf16 v[172:175], v[108:111], v[212:215], v[172:175]
    v_mul_f32 v234, v234, v146
    v_mul_f32 v235, v147, v147
    s_waitcnt lgkmcnt(2)
    v_mfma_f32_16x16x32_bf16 v[160:163], v[112:115], v[216:219], v[160:163]
    v_mul_f32 v152, v152, v232
    v_add_f32 v233, 1.0, v233
    v_mfma_f32_16x16x32_bf16 v[168:171], v[116:119], v[216:219], v[168:171]
    v_exp_f32 v234, v234
    s_waitcnt lgkmcnt(0)
    s_barrier
    ds_read_b128 v[208:211], v240 offset:0
    ds_read_b128 v[212:215], v240 offset:2048
    v_mfma_f32_16x16x32_bf16 v[164:167], v[112:115], v[220:223], v[164:167]
    ds_read_b128 v[216:219], v241 offset:0
    v_fma_f32 v235, v235, s12, v246
    v_rcp_f32 v233, v233
    v_mfma_f32_16x16x32_bf16 v[172:175], v[116:119], v[220:223], v[172:175]
    v_mul_f32 v154, v146, v154
    v_mfma_f32_16x16x32_bf16 v[160:163], v[120:123], v[224:227], v[160:163]
    ds_read_b128 v[220:223], v241 offset:2048
    v_mul_f32 v235, v235, v147
    v_mul_f32 v236, v148, v148
    v_mfma_f32_16x16x32_bf16 v[168:171], v[124:127], v[224:227], v[168:171]
    v_mul_f32 v153, v153, v233
    v_add_f32 v234, 1.0, v234
    v_mfma_f32_16x16x32_bf16 v[164:167], v[120:123], v[228:231], v[164:167]
    ds_read_b128 v[224:227], v240 offset:4096
    v_exp_f32 v235, v235
    v_mfma_f32_16x16x32_bf16 v[172:175], v[124:127], v[228:231], v[172:175]
    v_fma_f32 v236, v236, s12, v246
    v_rcp_f32 v234, v234
    s_waitcnt lgkmcnt(3)
    v_mfma_f32_16x16x32_bf16 v[128:131], v[0:3], v[208:211], 0
    ds_read_b128 v[228:231], v240 offset:6144
    v_mul_f32 v155, v147, v155
    v_mfma_f32_16x16x32_bf16 v[136:139], v[4:7], v[208:211], 0
    v_mul_f32 v236, v236, v148
    v_mul_f32 v237, v149, v149
    v_mfma_f32_16x16x32_bf16 v[132:135], v[0:3], v[212:215], 0
    ds_read_b128 v[208:211], v241 offset:4096
    v_cvt_pk_bf16_f32 v144, v152, v153
    v_mul_f32 v154, v154, v234
    v_mfma_f32_16x16x32_bf16 v[140:143], v[4:7], v[212:215], 0
    v_add_f32 v235, 1.0, v235
    v_exp_f32 v236, v236
    s_waitcnt lgkmcnt(3)
    v_mfma_f32_16x16x32_bf16 v[128:131], v[8:11], v[216:219], v[128:131]
    ds_read_b128 v[212:215], v241 offset:6144
    v_fma_f32 v237, v237, s12, v246
    v_mfma_f32_16x16x32_bf16 v[136:139], v[12:15], v[216:219], v[136:139]
    v_rcp_f32 v235, v235
    v_mfma_f32_16x16x32_bf16 v[132:135], v[8:11], v[220:223], v[132:135]
    ds_read_b128 v[216:219], v240 offset:8192
    v_mul_f32 v156, v148, v156
    v_mul_f32 v237, v237, v149
    v_mfma_f32_16x16x32_bf16 v[140:143], v[12:15], v[220:223], v[140:143]
    v_mul_f32 v238, v150, v150
    v_mul_f32 v155, v155, v235
    s_waitcnt lgkmcnt(3)
    v_mfma_f32_16x16x32_bf16 v[128:131], v[16:19], v[224:227], v[128:131]
    ds_read_b128 v[220:223], v240 offset:10240
    v_add_f32 v236, 1.0, v236
    v_exp_f32 v237, v237
    v_mfma_f32_16x16x32_bf16 v[136:139], v[20:23], v[224:227], v[136:139]
    v_fma_f32 v238, v238, s12, v246
    v_mfma_f32_16x16x32_bf16 v[132:135], v[16:19], v[228:231], v[132:135]
    ds_read_b128 v[224:227], v241 offset:8192
    v_rcp_f32 v236, v236
    v_mfma_f32_16x16x32_bf16 v[140:143], v[20:23], v[228:231], v[140:143]
    v_mul_f32 v157, v149, v157
    v_mul_f32 v238, v238, v150
    s_waitcnt lgkmcnt(3)
    v_mfma_f32_16x16x32_bf16 v[128:131], v[24:27], v[208:211], v[128:131]
    ds_read_b128 v[228:231], v241 offset:10240
    v_mul_f32 v239, v151, v151
    v_cvt_pk_bf16_f32 v145, v154, v155
    v_mfma_f32_16x16x32_bf16 v[136:139], v[28:31], v[208:211], v[136:139]
    v_mul_f32 v156, v156, v236
    v_add_f32 v237, 1.0, v237
    v_mfma_f32_16x16x32_bf16 v[132:135], v[24:27], v[212:215], v[132:135]
    ds_read_b128 v[208:211], v240 offset:12288
    v_exp_f32 v238, v238
    v_mfma_f32_16x16x32_bf16 v[140:143], v[28:31], v[212:215], v[140:143]
    v_fma_f32 v239, v239, s12, v246
    v_rcp_f32 v237, v237
    s_waitcnt lgkmcnt(3)
    v_mfma_f32_16x16x32_bf16 v[128:131], v[32:35], v[216:219], v[128:131]
    ds_read_b128 v[212:215], v240 offset:14336
    v_mul_f32 v158, v150, v158
    v_mfma_f32_16x16x32_bf16 v[136:139], v[36:39], v[216:219], v[136:139]
    v_mul_f32 v239, v239, v151
    v_mul_f32 v157, v157, v237
    v_mfma_f32_16x16x32_bf16 v[132:135], v[32:35], v[220:223], v[132:135]
    ds_read_b128 v[216:219], v241 offset:12288
    v_add_f32 v238, 1.0, v238
    v_exp_f32 v239, v239
    v_mfma_f32_16x16x32_bf16 v[140:143], v[36:39], v[220:223], v[140:143]
    v_rcp_f32 v238, v238
    s_waitcnt lgkmcnt(3)
    v_mfma_f32_16x16x32_bf16 v[128:131], v[40:43], v[224:227], v[128:131]
    ds_read_b128 v[220:223], v241 offset:14336
    v_mul_f32 v159, v151, v159
    v_mfma_f32_16x16x32_bf16 v[136:139], v[44:47], v[224:227], v[136:139]
    v_cvt_pk_bf16_f32 v146, v156, v157
    v_mul_f32 v158, v158, v238
    v_mfma_f32_16x16x32_bf16 v[132:135], v[40:43], v[228:231], v[132:135]
    v_add_f32 v239, 1.0, v239
    v_rcp_f32 v239, v239
    v_mfma_f32_16x16x32_bf16 v[140:143], v[44:47], v[228:231], v[140:143]
    v_mul_f32 v159, v159, v239
    s_waitcnt lgkmcnt(2)
    v_mfma_f32_16x16x32_bf16 v[128:131], v[48:51], v[208:211], v[128:131]
    v_cvt_pk_bf16_f32 v147, v158, v159
    v_permlane16_swap_b32 v144, v146
    v_mfma_f32_16x16x32_bf16 v[136:139], v[52:55], v[208:211], v[136:139]
    v_permlane16_swap_b32 v145, v147
    buffer_store_dwordx4 v[144:147], v245, s[52:55], s77 offen sc1
    s_waitcnt lgkmcnt(0)
    s_barrier
    ds_read_b128 v[224:227], v240 offset:16384
    ds_read_b128 v[228:231], v240 offset:18432
    v_mfma_f32_16x16x32_bf16 v[132:135], v[48:51], v[212:215], v[132:135]
    ds_read_b128 v[208:211], v241 offset:16384
    v_mul_f32 v232, v160, v160
    v_fma_f32 v232, v232, s12, v246
    v_mfma_f32_16x16x32_bf16 v[140:143], v[52:55], v[212:215], v[140:143]
    v_mul_f32 v232, v232, v160
    v_mul_f32 v233, v161, v161
    v_mfma_f32_16x16x32_bf16 v[128:131], v[56:59], v[216:219], v[128:131]
    ds_read_b128 v[212:215], v241 offset:18432
    v_exp_f32 v232, v232
    v_mfma_f32_16x16x32_bf16 v[136:139], v[60:63], v[216:219], v[136:139]
    v_fma_f32 v233, v233, s12, v246
    v_mul_f32 v168, v160, v168
    v_mfma_f32_16x16x32_bf16 v[132:135], v[56:59], v[220:223], v[132:135]
    ds_read_b128 v[216:219], v240 offset:20480
    v_mul_f32 v233, v233, v161
    v_mul_f32 v234, v162, v162
    v_mfma_f32_16x16x32_bf16 v[140:143], v[60:63], v[220:223], v[140:143]
    v_add_f32 v232, 1.0, v232
    v_exp_f32 v233, v233
    s_waitcnt lgkmcnt(3)
    v_mfma_f32_16x16x32_bf16 v[128:131], v[64:67], v[224:227], v[128:131]
    ds_read_b128 v[220:223], v240 offset:22528
    v_fma_f32 v234, v234, s12, v246
    v_mfma_f32_16x16x32_bf16 v[136:139], v[68:71], v[224:227], v[136:139]
    v_rcp_f32 v232, v232
    v_mfma_f32_16x16x32_bf16 v[132:135], v[64:67], v[228:231], v[132:135]
    ds_read_b128 v[224:227], v241 offset:20480
    v_mul_f32 v169, v161, v169
    v_mul_f32 v234, v234, v162
    v_mfma_f32_16x16x32_bf16 v[140:143], v[68:71], v[228:231], v[140:143]
    v_mul_f32 v235, v163, v163
    v_mul_f32 v168, v168, v232
    s_waitcnt lgkmcnt(3)
    v_mfma_f32_16x16x32_bf16 v[128:131], v[72:75], v[208:211], v[128:131]
    ds_read_b128 v[228:231], v241 offset:22528
    v_add_f32 v233, 1.0, v233
    v_exp_f32 v234, v234
    v_mfma_f32_16x16x32_bf16 v[136:139], v[76:79], v[208:211], v[136:139]
    v_fma_f32 v235, v235, s12, v246
    v_mfma_f32_16x16x32_bf16 v[132:135], v[72:75], v[212:215], v[132:135]
    ds_read_b128 v[208:211], v240 offset:24576
    v_rcp_f32 v233, v233
    v_mfma_f32_16x16x32_bf16 v[140:143], v[76:79], v[212:215], v[140:143]
    v_mul_f32 v170, v162, v170
    v_mul_f32 v235, v235, v163
    s_waitcnt lgkmcnt(3)
    v_mfma_f32_16x16x32_bf16 v[128:131], v[80:83], v[216:219], v[128:131]
    ds_read_b128 v[212:215], v240 offset:26624
    v_mul_f32 v236, v164, v164
    v_mul_f32 v169, v169, v233
    v_mfma_f32_16x16x32_bf16 v[136:139], v[84:87], v[216:219], v[136:139]
    v_add_f32 v234, 1.0, v234
    v_exp_f32 v235, v235
    v_mfma_f32_16x16x32_bf16 v[132:135], v[80:83], v[220:223], v[132:135]
    ds_read_b128 v[216:219], v241 offset:24576
    v_fma_f32 v236, v236, s12, v246
    v_mfma_f32_16x16x32_bf16 v[140:143], v[84:87], v[220:223], v[140:143]
    v_rcp_f32 v234, v234
    s_waitcnt lgkmcnt(3)
    v_mfma_f32_16x16x32_bf16 v[128:131], v[88:91], v[224:227], v[128:131]
    ds_read_b128 v[220:223], v241 offset:26624
    v_mul_f32 v171, v163, v171
    v_mul_f32 v236, v236, v164
    v_mfma_f32_16x16x32_bf16 v[136:139], v[92:95], v[224:227], v[136:139]
    v_mul_f32 v237, v165, v165
    v_cvt_pk_bf16_f32 v160, v168, v169
    v_mfma_f32_16x16x32_bf16 v[132:135], v[88:91], v[228:231], v[132:135]
    ds_read_b128 v[224:227], v240 offset:28672
    v_mul_f32 v170, v170, v234
    v_add_f32 v235, 1.0, v235
    v_mfma_f32_16x16x32_bf16 v[140:143], v[92:95], v[228:231], v[140:143]
    v_exp_f32 v236, v236
    s_waitcnt lgkmcnt(3)
    v_mfma_f32_16x16x32_bf16 v[128:131], v[96:99], v[208:211], v[128:131]
    ds_read_b128 v[228:231], v240 offset:30720
    v_fma_f32 v237, v237, s12, v246
    v_rcp_f32 v235, v235
    v_mfma_f32_16x16x32_bf16 v[136:139], v[100:103], v[208:211], v[136:139]
    v_mul_f32 v172, v164, v172
    v_mfma_f32_16x16x32_bf16 v[132:135], v[96:99], v[212:215], v[132:135]
    ds_read_b128 v[208:211], v241 offset:28672
    v_mul_f32 v237, v237, v165
    v_mul_f32 v238, v166, v166
    v_mfma_f32_16x16x32_bf16 v[140:143], v[100:103], v[212:215], v[140:143]
    v_mul_f32 v171, v171, v235
    v_add_f32 v236, 1.0, v236
    s_waitcnt lgkmcnt(3)
    v_mfma_f32_16x16x32_bf16 v[128:131], v[104:107], v[216:219], v[128:131]
    ds_read_b128 v[212:215], v241 offset:30720
    v_exp_f32 v237, v237
    v_mfma_f32_16x16x32_bf16 v[136:139], v[108:111], v[216:219], v[136:139]
    v_fma_f32 v238, v238, s12, v246
    v_rcp_f32 v236, v236
    v_mfma_f32_16x16x32_bf16 v[132:135], v[104:107], v[220:223], v[132:135]
    v_mul_f32 v173, v165, v173
    v_mfma_f32_16x16x32_bf16 v[140:143], v[108:111], v[220:223], v[140:143]
    v_mul_f32 v238, v238, v166
    v_mul_f32 v239, v167, v167
    s_waitcnt lgkmcnt(2)
    v_mfma_f32_16x16x32_bf16 v[128:131], v[112:115], v[224:227], v[128:131]
    v_cvt_pk_bf16_f32 v161, v170, v171
    v_mul_f32 v172, v172, v236
    v_mfma_f32_16x16x32_bf16 v[136:139], v[116:119], v[224:227], v[136:139]
    v_add_f32 v237, 1.0, v237
    v_exp_f32 v238, v238
    s_waitcnt lgkmcnt(0)
    s_branch L_pg1
.p2align 12
L_stub1:
    s_setpc_b64 s[98:99]
L_pg1:
    s_barrier
    ds_read_b128 v[216:219], v240 offset:32768
    ds_read_b128 v[220:223], v240 offset:34816
    v_mfma_f32_16x16x32_bf16 v[132:135], v[112:115], v[228:231], v[132:135]
    ds_read_b128 v[224:227], v241 offset:32768
    v_fma_f32 v239, v239, s12, v246
    v_mfma_f32_16x16x32_bf16 v[140:143], v[116:119], v[228:231], v[140:143]
    v_rcp_f32 v237, v237
    v_mfma_f32_16x16x32_bf16 v[128:131], v[120:123], v[208:211], v[128:131]
    ds_read_b128 v[228:231], v241 offset:34816
    v_mul_f32 v174, v166, v174
    v_mul_f32 v239, v239, v167
    v_mfma_f32_16x16x32_bf16 v[136:139], v[124:127], v[208:211], v[136:139]
    v_mul_f32 v173, v173, v237
    v_add_f32 v238, 1.0, v238
    v_mfma_f32_16x16x32_bf16 v[132:135], v[120:123], v[212:215], v[132:135]
    ds_read_b128 v[208:211], v240 offset:36864
    v_exp_f32 v239, v239
    v_mfma_f32_16x16x32_bf16 v[140:143], v[124:127], v[212:215], v[140:143]
    v_rcp_f32 v238, v238
    s_waitcnt lgkmcnt(3)
    v_mfma_f32_16x16x32_bf16 v[144:147], v[0:3], v[216:219], 0
    ds_read_b128 v[212:215], v240 offset:38912
    v_mul_f32 v175, v167, v175
    v_cvt_pk_bf16_f32 v162, v172, v173
    v_mfma_f32_16x16x32_bf16 v[152:155], v[4:7], v[216:219], 0
    v_mul_f32 v174, v174, v238
    v_add_f32 v239, 1.0, v239
    v_mfma_f32_16x16x32_bf16 v[148:151], v[0:3], v[220:223], 0
    ds_read_b128 v[216:219], v241 offset:36864
    v_rcp_f32 v239, v239
    v_mfma_f32_16x16x32_bf16 v[156:159], v[4:7], v[220:223], 0
    v_mul_f32 v175, v175, v239
    v_cvt_pk_bf16_f32 v163, v174, v175
    s_waitcnt lgkmcnt(3)
    v_mfma_f32_16x16x32_bf16 v[144:147], v[8:11], v[224:227], v[144:147]
    ds_read_b128 v[220:223], v241 offset:38912
    v_permlane16_swap_b32 v160, v162
    v_permlane16_swap_b32 v161, v163
    v_mfma_f32_16x16x32_bf16 v[152:155], v[12:15], v[224:227], v[152:155]
    buffer_store_dwordx4 v[160:163], v245, s[52:55], s78 offen sc1
    v_mul_f32 v232, v128, v128
    v_mfma_f32_16x16x32_bf16 v[148:151], v[8:11], v[228:231], v[148:151]
    ds_read_b128 v[224:227], v240 offset:40960
    v_mfma_f32_16x16x32_bf16 v[156:159], v[12:15], v[228:231], v[156:159]
    v_fma_f32 v232, v232, s12, v246
    v_mul_f32 v232, v232, v128
    s_waitcnt lgkmcnt(3)
    v_mfma_f32_16x16x32_bf16 v[144:147], v[16:19], v[208:211], v[144:147]
    ds_read_b128 v[228:231], v240 offset:43008
    v_mul_f32 v233, v129, v129
    v_exp_f32 v232, v232
    v_mfma_f32_16x16x32_bf16 v[152:155], v[20:23], v[208:211], v[152:155]
    v_fma_f32 v233, v233, s12, v246
    v_mfma_f32_16x16x32_bf16 v[148:151], v[16:19], v[212:215], v[148:151]
    ds_read_b128 v[208:211], v241 offset:40960
    v_mul_f32 v136, v128, v136
    v_mul_f32 v233, v233, v129
    v_mfma_f32_16x16x32_bf16 v[156:159], v[20:23], v[212:215], v[156:159]
    v_mul_f32 v234, v130, v130
    v_add_f32 v232, 1.0, v232
    s_waitcnt lgkmcnt(3)
    v_mfma_f32_16x16x32_bf16 v[144:147], v[24:27], v[216:219], v[144:147]
    ds_read_b128 v[212:215], v241 offset:43008
    v_exp_f32 v233, v233
    v_mfma_f32_16x16x32_bf16 v[152:155], v[28:31], v[216:219], v[152:155]
    v_fma_f32 v234, v234, s12, v246
    v_rcp_f32 v232, v232
    v_mfma_f32_16x16x32_bf16 v[148:151], v[24:27], v[220:223], v[148:151]
    ds_read_b128 v[216:219], v240 offset:45056
    v_mul_f32 v137, v129, v137
    v_mfma_f32_16x16x32_bf16 v[156:159], v[28:31], v[220:223], v[156:159]
    v_mul_f32 v234, v234, v130
    v_mul_f32 v235, v131, v131
    s_waitcnt lgkmcnt(3)
    v_mfma_f32_16x16x32_bf16 v[144:147], v[32:35], v[224:227], v[144:147]
    ds_read_b128 v[220:223], v240 offset:47104
    v_mul_f32 v136, v136, v232
    v_add_f32 v233, 1.0, v233
    v_mfma_f32_16x16x32_bf16 v[152:155], v[36:39], v[224:227], v[152:155]
    v_exp_f32 v234, v234
    v_mfma_f32_16x16x32_bf16 v[148:151], v[32:35], v[228:231], v[148:151]
    ds_read_b128 v[224:227], v241 offset:45056
    v_fma_f32 v235, v235, s12, v246
    v_rcp_f32 v233, v233
    v_mfma_f32_16x16x32_bf16 v[156:159], v[36:39], v[228:231], v[156:159]
    v_mul_f32 v138, v130, v138
    s_waitcnt lgkmcnt(3)
    v_mfma_f32_16x16x32_bf16 v[144:147], v[40:43], v[208:211], v[144:147]
    ds_read_b128 v[228:231], v241 offset:47104
    v_mul_f32 v235, v235, v131
    v_mul_f32 v236, v132, v132
    v_mfma_f32_16x16x32_bf16 v[152:155], v[44:47], v[208:211], v[152:155]
    v_mul_f32 v137, v137, v233
    v_add_f32 v234, 1.0, v234
    v_mfma_f32_16x16x32_bf16 v[148:151], v[40:43], v[212:215], v[148:151]
    v_exp_f32 v235, v235
    v_mfma_f32_16x16x32_bf16 v[156:159], v[44:47], v[212:215], v[156:159]
    v_fma_f32 v236, v236, s12, v246
    v_rcp_f32 v234, v234
    s_waitcnt lgkmcnt(2)
    v_mfma_f32_16x16x32_bf16 v[144:147], v[48:51], v[216:219], v[144:147]
    v_mul_f32 v139, v131, v139
    v_mfma_f32_16x16x32_bf16 v[152:155], v[52:55], v[216:219], v[152:155]
    v_mul_f32 v236, v236, v132
    v_mul_f32 v237, v133, v133
    s_waitcnt vmcnt(1) lgkmcnt(0)
    s_barrier
    ds_read_b128 v[208:211], v240 offset:0
    ds_read_b128 v[212:215], v240 offset:2048
    v_mfma_f32_16x16x32_bf16 v[148:151], v[48:51], v[220:223], v[148:151]
    ds_read_b128 v[216:219], v241 offset:0
    v_cvt_pk_bf16_f32 v128, v136, v137
    v_mul_f32 v138, v138, v234
    v_mfma_f32_16x16x32_bf16 v[156:159], v[52:55], v[220:223], v[156:159]
    v_add_f32 v235, 1.0, v235
    v_exp_f32 v236, v236
    v_mfma_f32_16x16x32_bf16 v[144:147], v[56:59], v[224:227], v[144:147]
    ds_read_b128 v[220:223], v241 offset:2048
    v_fma_f32 v237, v237, s12, v246
    v_mfma_f32_16x16x32_bf16 v[152:155], v[60:63], v[224:227], v[152:155]
    v_rcp_f32 v235, v235
    v_mfma_f32_16x16x32_bf16 v[148:151], v[56:59], v[228:231], v[148:151]
    ds_read_b128 v[224:227], v240 offset:4096
    v_mul_f32 v140, v132, v140
    v_mul_f32 v237, v237, v133
    v_mfma_f32_16x16x32_bf16 v[156:159], v[60:63], v[228:231], v[156:159]
    v_mul_f32 v238, v134, v134
    v_mul_f32 v139, v139, v235
    s_waitcnt lgkmcnt(3)
    v_mfma_f32_16x16x32_bf16 v[144:147], v[64:67], v[208:211], v[144:147]
    ds_read_b128 v[228:231], v240 offset:6144
    v_add_f32 v236, 1.0, v236
    v_exp_f32 v237, v237
    v_mfma_f32_16x16x32_bf16 v[152:155], v[68:71], v[208:211], v[152:155]
    v_fma_f32 v238, v238, s12, v246
    v_mfma_f32_16x16x32_bf16 v[148:151], v[64:67], v[212:215], v[148:151]
    ds_read_b128 v[208:211], v241 offset:4096
    v_rcp_f32 v236, v236
    v_mfma_f32_16x16x32_bf16 v[156:159], v[68:71], v[212:215], v[156:159]
    v_mul_f32 v141, v133, v141
    v_mul_f32 v238, v238, v134
    s_waitcnt lgkmcnt(3)
    v_mfma_f32_16x16x32_bf16 v[144:147], v[72:75], v[216:219], v[144:147]
    ds_read_b128 v[212:215], v241 offset:6144
    v_mul_f32 v239, v135, v135
    v_cvt_pk_bf16_f32 v129, v138, v139
    v_mfma_f32_16x16x32_bf16 v[152:155], v[76:79], v[216:219], v[152:155]
    v_mul_f32 v140, v140, v236
    v_add_f32 v237, 1.0, v237
    v_mfma_f32_16x16x32_bf16 v[148:151], v[72:75], v[220:223], v[148:151]
    ds_read_b128 v[216:219], v240 offset:8192
    v_exp_f32 v238, v238
    v_mfma_f32_16x16x32_bf16 v[156:159], v[76:79], v[220:223], v[156:159]
    v_fma_f32 v239, v239, s12, v246
    v_rcp_f32 v237, v237
    s_waitcnt lgkmcnt(3)
    v_mfma_f32_16x16x32_bf16 v[144:147], v[80:83], v[224:227], v[144:147]
    ds_read_b128 v[220:223], v240 offset:10240
    v_mul_f32 v142, v134, v142
    v_mfma_f32_16x16x32_bf16 v[152:155], v[84:87], v[224:227], v[152:155]
    v_mul_f32 v239, v239, v135
    v_mul_f32 v141, v141, v237
    v_mfma_f32_16x16x32_bf16 v[148:151], v[80:83], v[228:231], v[148:151]
    ds_read_b128 v[224:227], v241 offset:8192
    v_add_f32 v238, 1.0, v238
    v_exp_f32 v239, v239
    v_mfma_f32_16x16x32_bf16 v[156:159], v[84:87], v[228:231], v[156:159]
    v_rcp_f32 v238, v238
    s_waitcnt lgkmcnt(3)
    v_mfma_f32_16x16x32_bf16 v[144:147], v[88:91], v[208:211], v[144:147]
    ds_read_b128 v[228:231], v241 offset:10240
    v_mul_f32 v143, v135, v143
    v_mfma_f32_16x16x32_bf16 v[152:155], v[92:95], v[208:211], v[152:155]
    v_cvt_pk_bf16_f32 v130, v140, v141
    v_mul_f32 v142, v142, v238
    v_mfma_f32_16x16x32_bf16 v[148:151], v[88:91], v[212:215], v[148:151]
    ds_read_b128 v[208:211], v240 offset:12288
    v_add_f32 v239, 1.0, v239
    v_rcp_f32 v239, v239
    v_mfma_f32_16x16x32_bf16 v[156:159], v[92:95], v[212:215], v[156:159]
    v_mul_f32 v143, v143, v239
    s_waitcnt lgkmcnt(3)
    v_mfma_f32_16x16x32_bf16 v[144:147], v[96:99], v[216:219], v[144:147]
    ds_read_b128 v[212:215], v240 offset:14336
    v_cvt_pk_bf16_f32 v131, v142, v143
    v_permlane16_swap_b32 v128, v130
    v_mfma_f32_16x16x32_bf16 v[152:155], v[100:103], v[216:219], v[152:155]
    v_permlane16_swap_b32 v129, v131
    buffer_store_dwordx4 v[128:131], v245, s[52:55], s79 offen sc1
    v_mfma_f32_16x16x32_bf16 v[148:151], v[96:99], v[220:223], v[148:151]
    ds_read_b128 v[216:219], v241 offset:12288
    v_mfma_f32_16x16x32_bf16 v[156:159], v[100:103], v[220:223], v[156:159]
    s_waitcnt lgkmcnt(3)
    v_mfma_f32_16x16x32_bf16 v[144:147], v[104:107], v[224:227], v[144:147]
    ds_read_b128 v[220:223], v241 offset:14336
    v_mfma_f32_16x16x32_bf16 v[152:155], v[108:111], v[224:227], v[152:155]
    v_mfma_f32_16x16x32_bf16 v[148:151], v[104:107], v[228:231], v[148:151]
    v_mfma_f32_16x16x32_bf16 v[156:159], v[108:111], v[228:231], v[156:159]
    s_waitcnt lgkmcnt(2)
    v_mfma_f32_16x16x32_bf16 v[144:147], v[112:115], v[208:211], v[144:147]
    v_mfma_f32_16x16x32_bf16 v[152:155], v[116:119], v[208:211], v[152:155]
    s_waitcnt lgkmcnt(0)
    s_barrier
    ds_read_b128 v[224:227], v240 offset:16384
    ds_read_b128 v[228:231], v240 offset:18432
    v_mfma_f32_16x16x32_bf16 v[148:151], v[112:115], v[212:215], v[148:151]
    ds_read_b128 v[208:211], v241 offset:16384
    v_mfma_f32_16x16x32_bf16 v[156:159], v[116:119], v[212:215], v[156:159]
    v_mfma_f32_16x16x32_bf16 v[144:147], v[120:123], v[216:219], v[144:147]
    ds_read_b128 v[212:215], v241 offset:18432
    v_mfma_f32_16x16x32_bf16 v[152:155], v[124:127], v[216:219], v[152:155]
    v_mfma_f32_16x16x32_bf16 v[148:151], v[120:123], v[220:223], v[148:151]
    ds_read_b128 v[216:219], v240 offset:20480
    v_mfma_f32_16x16x32_bf16 v[156:159], v[124:127], v[220:223], v[156:159]
    s_waitcnt lgkmcnt(3)
    v_mfma_f32_16x16x32_bf16 v[160:163], v[0:3], v[224:227], 0
    ds_read_b128 v[220:223], v240 offset:22528
    v_mfma_f32_16x16x32_bf16 v[168:171], v[4:7], v[224:227], 0
    v_mfma_f32_16x16x32_bf16 v[164:167], v[0:3], v[228:231], 0
    ds_read_b128 v[224:227], v241 offset:20480
    v_mfma_f32_16x16x32_bf16 v[172:175], v[4:7], v[228:231], 0
    s_waitcnt lgkmcnt(3)
    v_mfma_f32_16x16x32_bf16 v[160:163], v[8:11], v[208:211], v[160:163]
    ds_read_b128 v[228:231], v241 offset:22528
    v_mfma_f32_16x16x32_bf16 v[168:171], v[12:15], v[208:211], v[168:171]
    v_mfma_f32_16x16x32_bf16 v[164:167], v[8:11], v[212:215], v[164:167]
    ds_read_b128 v[208:211], v240 offset:24576
    v_mfma_f32_16x16x32_bf16 v[172:175], v[12:15], v[212:215], v[172:175]
    v_mul_f32 v232, v144, v144
    v_fma_f32 v232, v232, s12, v246
    s_waitcnt lgkmcnt(3)
    v_mfma_f32_16x16x32_bf16 v[160:163], v[16:19], v[216:219], v[160:163]
    ds_read_b128 v[212:215], v240 offset:26624
    v_mul_f32 v232, v232, v144
    v_mul_f32 v233, v145, v145
    v_mfma_f32_16x16x32_bf16 v[168:171], v[20:23], v[216:219], v[168:171]
    v_exp_f32 v232, v232
    v_mfma_f32_16x16x32_bf16 v[164:167], v[16:19], v[220:223], v[164:167]
    ds_read_b128 v[216:219], v241 offset:24576
    v_fma_f32 v233, v233, s12, v246
    v_mul_f32 v152, v144, v152
    v_mfma_f32_16x16x32_bf16 v[172:175], v[20:23], v[220:223], v[172:175]
    v_mul_f32 v233, v233, v145
    v_mul_f32 v234, v146, v146
    s_waitcnt lgkmcnt(3)
    v_mfma_f32_16x16x32_bf16 v[160:163], v[24:27], v[224:227], v[160:163]
    ds_read_b128 v[220:223], v241 offset:26624
    v_add_f32 v232, 1.0, v232
    v_exp_f32 v233, v233
    v_mfma_f32_16x16x32_bf16 v[168:171], v[28:31], v[224:227], v[168:171]
    v_fma_f32 v234, v234, s12, v246
    v_mfma_f32_16x16x32_bf16 v[164:167], v[24:27], v[228:231], v[164:167]
    ds_read_b128 v[224:227], v240 offset:28672
    v_rcp_f32 v232, v232
    v_mfma_f32_16x16x32_bf16 v[172:175], v[28:31], v[228:231], v[172:175]
    v_mul_f32 v153, v145, v153
    v_mul_f32 v234, v234, v146
    s_waitcnt lgkmcnt(3)
    v_mfma_f32_16x16x32_bf16 v[160:163], v[32:35], v[208:211], v[160:163]
    ds_read_b128 v[228:231], v240 offset:30720
    v_mul_f32 v235, v147, v147
    v_mul_f32 v152, v152, v232
    v_mfma_f32_16x16x32_bf16 v[168:171], v[36:39], v[208:211], v[168:171]
    v_add_f32 v233, 1.0, v233
    v_exp_f32 v234, v234
    v_mfma_f32_16x16x32_bf16 v[164:167], v[32:35], v[212:215], v[164:167]
    ds_read_b128 v[208:211], v241 offset:28672
    v_fma_f32 v235, v235, s12, v246
    v_mfma_f32_16x16x32_bf16 v[172:175], v[36:39], v[212:215], v[172:175]
    v_rcp_f32 v233, v233
    s_waitcnt lgkmcnt(3)
    v_mfma_f32_16x16x32_bf16 v[160:163], v[40:43], v[216:219], v[160:163]
    ds_read_b128 v[212:215], v241 offset:30720
    v_mul_f32 v154, v146, v154
    v_mul_f32 v235, v235, v147
    v_mfma_f32_16x16x32_bf16 v[168:171], v[44:47], v[216:219], v[168:171]
    v_mul_f32 v236, v148, v148
    v_mul_f32 v153, v153, v233
    v_mfma_f32_16x16x32_bf16 v[164:167], v[40:43], v[220:223], v[164:167]
    v_add_f32 v234, 1.0, v234
    v_exp_f32 v235, v235
    v_mfma_f32_16x16x32_bf16 v[172:175], v[44:47], v[220:223], v[172:175]
    v_fma_f32 v236, v236, s12, v246
    s_waitcnt lgkmcnt(2)
    v_mfma_f32_16x16x32_bf16 v[160:163], v[48:51], v[224:227], v[160:163]
    v_rcp_f32 v234, v234
    v_mfma_f32_16x16x32_bf16 v[168:171], v[52:55], v[224:227], v[168:171]
    v_mul_f32 v155, v147, v155
    v_mul_f32 v236, v236, v148
    s_waitcnt lgkmcnt(0)
    s_barrier
    ds_read_b128 v[216:219], v240 offset:32768
    ds_read_b128 v[220:223], v240 offset:34816
    v_mfma_f32_16x16x32_bf16 v[164:167], v[48:51], v[228:231], v[164:167]
    ds_read_b128 v[224:227], v241 offset:32768
    v_mul_f32 v237, v149, v149
    v_cvt_pk_bf16_f32 v144, v152, v153
    v_mfma_f32_16x16x32_bf16 v[172:175], v[52:55], v[228:231], v[172:175]
    v_mul_f32 v154, v154, v234
    v_add_f32 v235, 1.0, v235
    v_mfma_f32_16x16x32_bf16 v[160:163], v[56:59], v[208:211], v[160:163]
    ds_read_b128 v[228:231], v241 offset:34816
    v_exp_f32 v236, v236
    v_mfma_f32_16x16x32_bf16 v[168:171], v[60:63], v[208:211], v[168:171]
    v_fma_f32 v237, v237, s12, v246
    v_rcp_f32 v235, v235
    v_mfma_f32_16x16x32_bf16 v[164:167], v[56:59], v[212:215], v[164:167]
    ds_read_b128 v[208:211], v240 offset:36864
    v_mul_f32 v156, v148, v156
    v_mfma_f32_16x16x32_bf16 v[172:175], v[60:63], v[212:215], v[172:175]
    v_mul_f32 v237, v237, v149
    v_mul_f32 v238, v150, v150
    s_waitcnt lgkmcnt(3)
    v_mfma_f32_16x16x32_bf16 v[160:163], v[64:67], v[216:219], v[160:163]
    ds_read_b128 v[212:215], v240 offset:38912
    v_mul_f32 v155, v155, v235
    v_add_f32 v236, 1.0, v236
    v_mfma_f32_16x16x32_bf16 v[168:171], v[68:71], v[216:219], v[168:171]
    v_exp_f32 v237, v237
    v_mfma_f32_16x16x32_bf16 v[164:167], v[64:67], v[220:223], v[164:167]
    ds_read_b128 v[216:219], v241 offset:36864
    v_fma_f32 v238, v238, s12, v246
    v_rcp_f32 v236, v236
    v_mfma_f32_16x16x32_bf16 v[172:175], v[68:71], v[220:223], v[172:175]
    v_mul_f32 v157, v149, v157
    s_waitcnt lgkmcnt(3)
    v_mfma_f32_16x16x32_bf16 v[160:163], v[72:75], v[224:227], v[160:163]
    ds_read_b128 v[220:223], v241 offset:38912
    v_mul_f32 v238, v238, v150
    v_mul_f32 v239, v151, v151
    v_mfma_f32_16x16x32_bf16 v[168:171], v[76:79], v[224:227], v[168:171]
    v_cvt_pk_bf16_f32 v145, v154, v155
    v_mul_f32 v156, v156, v236
    v_mfma_f32_16x16x32_bf16 v[164:167], v[72:75], v[228:231], v[164:167]
    ds_read_b128 v[224:227], v240 offset:40960
    v_add_f32 v237, 1.0, v237
    v_exp_f32 v238, v238
    v_mfma_f32_16x16x32_bf16 v[172:175], v[76:79], v[228:231], v[172:175]
    v_fma_f32 v239, v239, s12, v246
    s_waitcnt lgkmcnt(3)
    v_mfma_f32_16x16x32_bf16 v[160:163], v[80:83], v[208:211], v[160:163]
    ds_read_b128 v[228:231], v240 offset:43008
    v_rcp_f32 v237, v237
    v_mfma_f32_16x16x32_bf16 v[168:171], v[84:87], v[208:211], v[168:171]
    v_mul_f32 v158, v150, v158
    v_mul_f32 v239, v239, v151
    v_mfma_f32_16x16x32_bf16 v[164:167], v[80:83], v[212:215], v[164:167]
    ds_read_b128 v[208:211], v241 offset:40960
    v_mul_f32 v157, v157, v237
    v_add_f32 v238, 1.0, v238
    v_mfma_f32_16x16x32_bf16 v[172:175], v[84:87], v[212:215], v[172:175]
    v_exp_f32 v239, v239
    s_waitcnt lgkmcnt(3)
    v_mfma_f32_16x16x32_bf16 v[160:163], v[88:91], v[216:219], v[160:163]
    ds_read_b128 v[212:215], v241 offset:43008
    v_rcp_f32 v238, v238
    v_mfma_f32_16x16x32_bf16 v[168:171], v[92:95], v[216:219], v[168:171]
    v_mul_f32 v159, v151, v159
    v_cvt_pk_bf16_f32 v146, v156, v157
    v_mfma_f32_16x16x32_bf16 v[164:167], v[88:91], v[220:223], v[164:167]
    ds_read_b128 v[216:219], v240 offset:45056
    v_mul_f32 v158, v158, v238
    v_add_f32 v239, 1.0, v239
    v_mfma_f32_16x16x32_bf16 v[172:175], v[92:95], v[220:223], v[172:175]
    v_rcp_f32 v239, v239
    s_waitcnt lgkmcnt(3)
    v_mfma_f32_16x16x32_bf16 v[160:163], v[96:99], v[224:227], v[160:163]
    ds_read_b128 v[220:223], v240 offset:47104
    v_mul_f32 v159, v159, v239
    v_cvt_pk_bf16_f32 v147, v158, v159
    v_mfma_f32_16x16x32_bf16 v[168:171], v[100:103], v[224:227], v[168:171]
    v_permlane16_swap_b32 v144, v146
    v_permlane16_swap_b32 v145, v147
    v_mfma_f32_16x16x32_bf16 v[164:167], v[96:99], v[228:231], v[164:167]
    ds_read_b128 v[224:227], v241 offset:45056
    buffer_store_dwordx4 v[144:147], v245, s[52:55], s80 offen sc1
    v_mfma_f32_16x16x32_bf16 v[172:175], v[100:103], v[228:231], v[172:175]
    s_waitcnt lgkmcnt(3)
    v_mfma_f32_16x16x32_bf16 v[160:163], v[104:107], v[208:211], v[160:163]
    ds_read_b128 v[228:231], v241 offset:47104
    v_mfma_f32_16x16x32_bf16 v[168:171], v[108:111], v[208:211], v[168:171]
    v_mfma_f32_16x16x32_bf16 v[164:167], v[104:107], v[212:215], v[164:167]
    v_mfma_f32_16x16x32_bf16 v[172:175], v[108:111], v[212:215], v[172:175]
    s_waitcnt lgkmcnt(2)
    v_mfma_f32_16x16x32_bf16 v[160:163], v[112:115], v[216:219], v[160:163]
    v_mfma_f32_16x16x32_bf16 v[168:171], v[116:119], v[216:219], v[168:171]
    s_waitcnt vmcnt(1) lgkmcnt(0)
    s_barrier
    ds_read_b128 v[208:211], v240 offset:0
    ds_read_b128 v[212:215], v240 offset:2048
    v_mfma_f32_16x16x32_bf16 v[164:167], v[112:115], v[220:223], v[164:167]
    ds_read_b128 v[216:219], v241 offset:0
    v_mfma_f32_16x16x32_bf16 v[172:175], v[116:119], v[220:223], v[172:175]
    v_mfma_f32_16x16x32_bf16 v[160:163], v[120:123], v[224:227], v[160:163]
    ds_read_b128 v[220:223], v241 offset:2048
    v_mfma_f32_16x16x32_bf16 v[168:171], v[124:127], v[224:227], v[168:171]
    v_mfma_f32_16x16x32_bf16 v[164:167], v[120:123], v[228:231], v[164:167]
    ds_read_b128 v[224:227], v240 offset:4096
    v_mfma_f32_16x16x32_bf16 v[172:175], v[124:127], v[228:231], v[172:175]
    s_waitcnt lgkmcnt(3)
    v_mfma_f32_16x16x32_bf16 v[128:131], v[0:3], v[208:211], 0
    ds_read_b128 v[228:231], v240 offset:6144
    v_mfma_f32_16x16x32_bf16 v[136:139], v[4:7], v[208:211], 0
    v_mfma_f32_16x16x32_bf16 v[132:135], v[0:3], v[212:215], 0
    ds_read_b128 v[208:211], v241 offset:4096
    v_mfma_f32_16x16x32_bf16 v[140:143], v[4:7], v[212:215], 0
    s_waitcnt lgkmcnt(3)
    v_mfma_f32_16x16x32_bf16 v[128:131], v[8:11], v[216:219], v[128:131]
    ds_read_b128 v[212:215], v241 offset:6144
    v_mfma_f32_16x16x32_bf16 v[136:139], v[12:15], v[216:219], v[136:139]
    v_mfma_f32_16x16x32_bf16 v[132:135], v[8:11], v[220:223], v[132:135]
    ds_read_b128 v[216:219], v240 offset:8192
    v_mfma_f32_16x16x32_bf16 v[140:143], v[12:15], v[220:223], v[140:143]
    v_mul_f32 v232, v160, v160
    v_fma_f32 v232, v232, s12, v246
    s_waitcnt lgkmcnt(3)
    v_mfma_f32_16x16x32_bf16 v[128:131], v[16:19], v[224:227], v[128:131]
    ds_read_b128 v[220:223], v240 offset:10240
    v_mul_f32 v232, v232, v160
    v_mul_f32 v233, v161, v161
    v_mfma_f32_16x16x32_bf16 v[136:139], v[20:23], v[224:227], v[136:139]
    v_exp_f32 v232, v232
    v_mfma_f32_16x16x32_bf16 v[132:135], v[16:19], v[228:231], v[132:135]
    ds_read_b128 v[224:227], v241 offset:8192
    v_fma_f32 v233, v233, s12, v246
    v_mul_f32 v168, v160, v168
    v_mfma_f32_16x16x32_bf16 v[140:143], v[20:23], v[228:231], v[140:143]
    v_mul_f32 v233, v233, v161
    v_mul_f32 v234, v162, v162
    s_waitcnt lgkmcnt(3)
    v_mfma_f32_16x16x32_bf16 v[128:131], v[24:27], v[208:211], v[128:131]
    ds_read_b128 v[228:231], v241 offset:10240
    v_add_f32 v232, 1.0, v232
    v_exp_f32 v233, v233
    v_mfma_f32_16x16x32_bf16 v[136:139], v[28:31], v[208:211], v[136:139]
    v_fma_f32 v234, v234, s12, v246
    v_mfma_f32_16x16x32_bf16 v[132:135], v[24:27], v[212:215], v[132:135]
    ds_read_b128 v[208:211], v240 offset:12288
    v_rcp_f32 v232, v232
    v_mfma_f32_16x16x32_bf16 v[140:143], v[28:31], v[212:215], v[140:143]
    v_mul_f32 v169, v161, v169
    v_mul_f32 v234, v234, v162
    s_waitcnt lgkmcnt(3)
    v_mfma_f32_16x16x32_bf16 v[128:131], v[32:35], v[216:219], v[128:131]
    ds_read_b128 v[212:215], v240 offset:14336
    v_mul_f32 v235, v163, v163
    v_mul_f32 v168, v168, v232
    v_mfma_f32_16x16x32_bf16 v[136:139], v[36:39], v[216:219], v[136:139]
    v_add_f32 v233, 1.0, v233
    v_exp_f32 v234, v234
    v_mfma_f32_16x16x32_bf16 v[132:135], v[32:35], v[220:223], v[132:135]
    ds_read_b128 v[216:219], v241 offset:12288
    v_fma_f32 v235, v235, s12, v246
    v_mfma_f32_16x16x32_bf16 v[140:143], v[36:39], v[220:223], v[140:143]
    v_rcp_f32 v233, v233
    s_waitcnt lgkmcnt(3)
    v_mfma_f32_16x16x32_bf16 v[128:131], v[40:43], v[224:227], v[128:131]
    ds_read_b128 v[220:223], v241 offset:14336
    v_mul_f32 v170, v162, v170
    v_mul_f32 v235, v235, v163
    v_mfma_f32_16x16x32_bf16 v[136:139], v[44:47], v[224:227], v[136:139]
    v_mul_f32 v236, v164, v164
    v_mul_f32 v169, v169, v233
    v_mfma_f32_16x16x32_bf16 v[132:135], v[40:43], v[228:231], v[132:135]
    v_add_f32 v234, 1.0, v234
    v_exp_f32 v235, v235
    v_mfma_f32_16x16x32_bf16 v[140:143], v[44:47], v[228:231], v[140:143]
    v_fma_f32 v236, v236, s12, v246
    s_waitcnt lgkmcnt(2)
    v_mfma_f32_16x16x32_bf16 v[128:131], v[48:51], v[208:211], v[128:131]
    v_rcp_f32 v234, v234
    v_mfma_f32_16x16x32_bf16 v[136:139], v[52:55], v[208:211], v[136:139]
    v_mul_f32 v171, v163, v171
    v_mul_f32 v236, v236, v164
    s_waitcnt lgkmcnt(0)
    s_barrier
    ds_read_b128 v[224:227], v240 offset:16384
    ds_read_b128 v[228:231], v240 offset:18432
    v_mfma_f32_16x16x32_bf16 v[132:135], v[48:51], v[212:215], v[132:135]
    ds_read_b128 v[208:211], v241 offset:16384
    v_mul_f32 v237, v165, v165
    v_cvt_pk_bf16_f32 v160, v168, v169
    v_mfma_f32_16x16x32_bf16 v[140:143], v[52:55], v[212:215], v[140:143]
    v_mul_f32 v170, v170, v234
    v_add_f32 v235, 1.0, v235
    v_mfma_f32_16x16x32_bf16 v[128:131], v[56:59], v[216:219], v[128:131]
    ds_read_b128 v[212:215], v241 offset:18432
    v_exp_f32 v236, v236
    v_mfma_f32_16x16x32_bf16 v[136:139], v[60:63], v[216:219], v[136:139]
    v_fma_f32 v237, v237, s12, v246
    v_rcp_f32 v235, v235
    v_mfma_f32_16x16x32_bf16 v[132:135], v[56:59], v[220:223], v[132:135]
    ds_read_b128 v[216:219], v240 offset:20480
    v_mul_f32 v172, v164, v172
    v_mfma_f32_16x16x32_bf16 v[140:143], v[60:63], v[220:223], v[140:143]
    v_mul_f32 v237, v237, v165
    v_mul_f32 v238, v166, v166
    s_waitcnt lgkmcnt(3)
    v_mfma_f32_16x16x32_bf16 v[128:131], v[64:67], v[224:227], v[128:131]
    ds_read_b128 v[220:223], v240 offset:22528
    v_mul_f32 v171, v171, v235
    v_add_f32 v236, 1.0, v236
    v_mfma_f32_16x16x32_bf16 v[136:139], v[68:71], v[224:227], v[136:139]
    v_exp_f32 v237, v237
    v_mfma_f32_16x16x32_bf16 v[132:135], v[64:67], v[228:231], v[132:135]
    ds_read_b128 v[224:227], v241 offset:20480
    v_fma_f32 v238, v238, s12, v246
    v_rcp_f32 v236, v236
    v_mfma_f32_16x16x32_bf16 v[140:143], v[68:71], v[228:231], v[140:143]
    v_mul_f32 v173, v165, v173
    s_waitcnt lgkmcnt(3)
    v_mfma_f32_16x16x32_bf16 v[128:131], v[72:75], v[208:211], v[128:131]
    ds_read_b128 v[228:231], v241 offset:22528
    v_mul_f32 v238, v238, v166
    v_mul_f32 v239, v167, v167
    v_mfma_f32_16x16x32_bf16 v[136:139], v[76:79], v[208:211], v[136:139]
    v_cvt_pk_bf16_f32 v161, v170, v171
    v_mul_f32 v172, v172, v236
    v_mfma_f32_16x16x32_bf16 v[132:135], v[72:75], v[212:215], v[132:135]
    ds_read_b128 v[208:211], v240 offset:24576
    v_add_f32 v237, 1.0, v237
    v_exp_f32 v238, v238
    v_mfma_f32_16x16x32_bf16 v[140:143], v[76:79], v[212:215], v[140:143]
    v_fma_f32 v239, v239, s12, v246
    s_waitcnt lgkmcnt(3)
    v_mfma_f32_16x16x32_bf16 v[128:131], v[80:83], v[216:219], v[128:131]
    ds_read_b128 v[212:215], v240 offset:26624
    v_rcp_f32 v237, v237
    v_mfma_f32_16x16x32_bf16 v[136:139], v[84:87], v[216:219], v[136:139]
    v_mul_f32 v174, v166, v174
    v_mul_f32 v239, v239, v167
    v_mfma_f32_16x16x32_bf16 v[132:135], v[80:83], v[220:223], v[132:135]
    ds_read_b128 v[216:219], v241 offset:24576
    v_mul_f32 v173, v173, v237
    v_add_f32 v238, 1.0, v238
    v_mfma_f32_16x16x32_bf16 v[140:143], v[84:87], v[220:223], v[140:143]
    v_exp_f32 v239, v239
    s_waitcnt lgkmcnt(3)
    v_mfma_f32_16x16x32_bf16 v[128:131], v[88:91], v[224:227], v[128:131]
    ds_read_b128 v[220:223], v241 offset:26624
    v_rcp_f32 v238, v238
    v_mfma_f32_16x16x32_bf16 v[136:139], v[92:95], v[224:227], v[136:139]
    v_mul_f32 v175, v167, v175
    v_cvt_pk_bf16_f32 v162, v172, v173
    v_mfma_f32_16x16x32_bf16 v[132:135], v[88:91], v[228:231], v[132:135]
    ds_read_b128 v[224:227], v240 offset:28672
    v_mul_f32 v174, v174, v238
    v_add_f32 v239, 1.0, v239
    v_mfma_f32_16x16x32_bf16 v[140:143], v[92:95], v[228:231], v[140:143]
    v_rcp_f32 v239, v239
    s_waitcnt lgkmcnt(3)
    v_mfma_f32_16x16x32_bf16 v[128:131], v[96:99], v[208:211], v[128:131]
    ds_read_b128 v[228:231], v240 offset:30720
    v_mul_f32 v175, v175, v239
    v_cvt_pk_bf16_f32 v163, v174, v175
    v_mfma_f32_16x16x32_bf16 v[136:139], v[100:103], v[208:211], v[136:139]
    v_permlane16_swap_b32 v160, v162
    v_permlane16_swap_b32 v161, v163
    v_mfma_f32_16x16x32_bf16 v[132:135], v[96:99], v[212:215], v[132:135]
    ds_read_b128 v[208:211], v241 offset:28672
    buffer_store_dwordx4 v[160:163], v245, s[52:55], s81 offen sc1
    v_mfma_f32_16x16x32_bf16 v[140:143], v[100:103], v[212:215], v[140:143]
    s_waitcnt lgkmcnt(3)
    v_mfma_f32_16x16x32_bf16 v[128:131], v[104:107], v[216:219], v[128:131]
    ds_read_b128 v[212:215], v241 offset:30720
    v_mfma_f32_16x16x32_bf16 v[136:139], v[108:111], v[216:219], v[136:139]
    v_mfma_f32_16x16x32_bf16 v[132:135], v[104:107], v[220:223], v[132:135]
    v_mfma_f32_16x16x32_bf16 v[140:143], v[108:111], v[220:223], v[140:143]
    s_waitcnt lgkmcnt(2)
    v_mfma_f32_16x16x32_bf16 v[128:131], v[112:115], v[224:227], v[128:131]
    v_mfma_f32_16x16x32_bf16 v[136:139], v[116:119], v[224:227], v[136:139]
    s_waitcnt lgkmcnt(0)
    s_branch L_pg2
.p2align 12
L_stub2:
    s_setpc_b64 s[98:99]
L_pg2:
    s_barrier
    ds_read_b128 v[216:219], v240 offset:32768
    ds_read_b128 v[220:223], v240 offset:34816
    v_mfma_f32_16x16x32_bf16 v[132:135], v[112:115], v[228:231], v[132:135]
    ds_read_b128 v[224:227], v241 offset:32768
    v_mfma_f32_16x16x32_bf16 v[140:143], v[116:119], v[228:231], v[140:143]
    v_mfma_f32_16x16x32_bf16 v[128:131], v[120:123], v[208:211], v[128:131]
    ds_read_b128 v[228:231], v241 offset:34816
    v_mfma_f32_16x16x32_bf16 v[136:139], v[124:127], v[208:211], v[136:139]
    v_mfma_f32_16x16x32_bf16 v[132:135], v[120:123], v[212:215], v[132:135]
    ds_read_b128 v[208:211], v240 offset:36864
    v_mfma_f32_16x16x32_bf16 v[140:143], v[124:127], v[212:215], v[140:143]
    s_waitcnt lgkmcnt(3)
    v_mfma_f32_16x16x32_bf16 v[144:147], v[0:3], v[216:219], 0
    ds_read_b128 v[212:215], v240 offset:38912
    v_mfma_f32_16x16x32_bf16 v[152:155], v[4:7], v[216:219], 0
    v_mfma_f32_16x16x32_bf16 v[148:151], v[0:3], v[220:223], 0
    ds_read_b128 v[216:219], v241 offset:36864
    v_mfma_f32_16x16x32_bf16 v[156:159], v[4:7], v[220:223], 0
    s_waitcnt lgkmcnt(3)
    v_mfma_f32_16x16x32_bf16 v[144:147], v[8:11], v[224:227], v[144:147]
    ds_read_b128 v[220:223], v241 offset:38912
    buffer_load_dwordx4 v[0:3], v180, s[52:55], s60 offen offset:0 sc1
    v_mfma_f32_16x16x32_bf16 v[152:155], v[12:15], v[224:227], v[152:155]
    v_mfma_f32_16x16x32_bf16 v[148:151], v[8:11], v[228:231], v[148:151]
    ds_read_b128 v[224:227], v240 offset:40960
    v_mfma_f32_16x16x32_bf16 v[156:159], v[12:15], v[228:231], v[156:159]
    v_mul_f32 v232, v128, v128
    v_fma_f32 v232, v232, s12, v246
    s_waitcnt lgkmcnt(3)
    v_mfma_f32_16x16x32_bf16 v[144:147], v[16:19], v[208:211], v[144:147]
    ds_read_b128 v[228:231], v240 offset:43008
    buffer_load_dwordx4 v[4:7], v180, s[52:55], s60 offen offset:256 sc1
    v_mul_f32 v232, v232, v128
    v_mul_f32 v233, v129, v129
    v_mfma_f32_16x16x32_bf16 v[152:155], v[20:23], v[208:211], v[152:155]
    v_exp_f32 v232, v232
    v_mfma_f32_16x16x32_bf16 v[148:151], v[16:19], v[212:215], v[148:151]
    ds_read_b128 v[208:211], v241 offset:40960
    v_fma_f32 v233, v233, s12, v246
    v_mul_f32 v136, v128, v136
    v_mfma_f32_16x16x32_bf16 v[156:159], v[20:23], v[212:215], v[156:159]
    v_mul_f32 v233, v233, v129
    v_mul_f32 v234, v130, v130
    s_waitcnt lgkmcnt(3)
    v_mfma_f32_16x16x32_bf16 v[144:147], v[24:27], v[216:219], v[144:147]
    ds_read_b128 v[212:215], v241 offset:43008
    buffer_load_dwordx4 v[8:11], v180, s[52:55], s60 offen offset:2048 sc1
    v_add_f32 v232, 1.0, v232
    v_exp_f32 v233, v233
    v_mfma_f32_16x16x32_bf16 v[152:155], v[28:31], v[216:219], v[152:155]
    v_fma_f32 v234, v234, s12, v246
    v_mfma_f32_16x16x32_bf16 v[148:151], v[24:27], v[220:223], v[148:151]
    ds_read_b128 v[216:219], v240 offset:45056
    v_rcp_f32 v232, v232
    v_mfma_f32_16x16x32_bf16 v[156:159], v[28:31], v[220:223], v[156:159]
    v_mul_f32 v137, v129, v137
    v_mul_f32 v234, v234, v130
    s_waitcnt lgkmcnt(3)
    v_mfma_f32_16x16x32_bf16 v[144:147], v[32:35], v[224:227], v[144:147]
    ds_read_b128 v[220:223], v240 offset:47104
    buffer_load_dwordx4 v[12:15], v180, s[52:55], s60 offen offset:2304 sc1
    v_mul_f32 v235, v131, v131
    v_mul_f32 v136, v136, v232
    v_mfma_f32_16x16x32_bf16 v[152:155], v[36:39], v[224:227], v[152:155]
    v_add_f32 v233, 1.0, v233
    v_exp_f32 v234, v234
    v_mfma_f32_16x16x32_bf16 v[148:151], v[32:35], v[228:231], v[148:151]
    ds_read_b128 v[224:227], v241 offset:45056
    v_fma_f32 v235, v235, s12, v246
    v_mfma_f32_16x16x32_bf16 v[156:159], v[36:39], v[228:231], v[156:159]
    v_rcp_f32 v233, v233
    s_waitcnt lgkmcnt(3)
    v_mfma_f32_16x16x32_bf16 v[144:147], v[40:43], v[208:211], v[144:147]
    ds_read_b128 v[228:231], v241 offset:47104
    buffer_load_dwordx4 v[16:19], v180, s[52:55], s61 offen offset:0 sc1
    v_mul_f32 v138, v130, v138
    v_mul_f32 v235, v235, v131
    v_mfma_f32_16x16x32_bf16 v[152:155], v[44:47], v[208:211], v[152:155]
    v_mul_f32 v236, v132, v132
    v_mul_f32 v137, v137, v233
    v_mfma_f32_16x16x32_bf16 v[148:151], v[40:43], v[212:215], v[148:151]
    v_add_f32 v234, 1.0, v234
    v_exp_f32 v235, v235
    v_mfma_f32_16x16x32_bf16 v[156:159], v[44:47], v[212:215], v[156:159]
    v_fma_f32 v236, v236, s12, v246
    s_waitcnt lgkmcnt(2)
    v_mfma_f32_16x16x32_bf16 v[144:147], v[48:51], v[216:219], v[144:147]
    v_rcp_f32 v234, v234
    v_mfma_f32_16x16x32_bf16 v[152:155], v[52:55], v[216:219], v[152:155]
    v_mul_f32 v139, v131, v139
    v_mul_f32 v236, v236, v132
    s_waitcnt vmcnt(5) lgkmcnt(0)
    s_barrier
    ds_read_b128 v[208:211], v240 offset:0
    ds_read_b128 v[212:215], v240 offset:2048
    v_mfma_f32_16x16x32_bf16 v[148:151], v[48:51], v[220:223], v[148:151]
    ds_read_b128 v[216:219], v241 offset:0
    v_mul_f32 v237, v133, v133
    v_cvt_pk_bf16_f32 v128, v136, v137
    v_mfma_f32_16x16x32_bf16 v[156:159], v[52:55], v[220:223], v[156:159]
    v_mul_f32 v138, v138, v234
    v_add_f32 v235, 1.0, v235
    v_mfma_f32_16x16x32_bf16 v[144:147], v[56:59], v[224:227], v[144:147]
    ds_read_b128 v[220:223], v241 offset:2048
    buffer_load_dwordx4 v[20:23], v180, s[52:55], s61 offen offset:256 sc1
    v_exp_f32 v236, v236
    v_mfma_f32_16x16x32_bf16 v[152:155], v[60:63], v[224:227], v[152:155]
    v_fma_f32 v237, v237, s12, v246
    v_rcp_f32 v235, v235
    v_mfma_f32_16x16x32_bf16 v[148:151], v[56:59], v[228:231], v[148:151]
    ds_read_b128 v[224:227], v240 offset:4096
    v_mul_f32 v140, v132, v140
    v_mfma_f32_16x16x32_bf16 v[156:159], v[60:63], v[228:231], v[156:159]
    v_mul_f32 v237, v237, v133
    v_mul_f32 v238, v134, v134
    s_waitcnt lgkmcnt(3)
    v_mfma_f32_16x16x32_bf16 v[144:147], v[64:67], v[208:211], v[144:147]
    ds_read_b128 v[228:231], v240 offset:6144
    buffer_load_dwordx4 v[24:27], v180, s[52:55], s61 offen offset:2048 sc1
    v_mul_f32 v139, v139, v235
    v_add_f32 v236, 1.0, v236
    v_mfma_f32_16x16x32_bf16 v[152:155], v[68:71], v[208:211], v[152:155]
    v_exp_f32 v237, v237
    v_mfma_f32_16x16x32_bf16 v[148:151], v[64:67], v[212:215], v[148:151]
    ds_read_b128 v[208:211], v241 offset:4096
    v_fma_f32 v238, v238, s12, v246
    v_rcp_f32 v236, v236
    v_mfma_f32_16x16x32_bf16 v[156:159], v[68:71], v[212:215], v[156:159]
    v_mul_f32 v141, v133, v141
    s_waitcnt lgkmcnt(3)
    v_mfma_f32_16x16x32_bf16 v[144:147], v[72:75], v[216:219], v[144:147]
    ds_read_b128 v[212:215], v241 offset:6144
    buffer_load_dwordx4 v[28:31], v180, s[52:55], s61 offen offset:2304 sc1
    v_mul_f32 v238, v238, v134
    v_mul_f32 v239, v135, v135
    v_mfma_f32_16x16x32_bf16 v[152:155], v[76:79], v[216:219], v[152:155]
    v_cvt_pk_bf16_f32 v129, v138, v139
    v_mul_f32 v140, v140, v236
    v_mfma_f32_16x16x32_bf16 v[148:151], v[72:75], v[220:223], v[148:151]
    ds_read_b128 v[216:219], v240 offset:8192
    v_add_f32 v237, 1.0, v237
    v_exp_f32 v238, v238
    v_mfma_f32_16x16x32_bf16 v[156:159], v[76:79], v[220:223], v[156:159]
    v_fma_f32 v239, v239, s12, v246
    s_waitcnt lgkmcnt(3)
    v_mfma_f32_16x16x32_bf16 v[144:147], v[80:83], v[224:227], v[144:147]
    ds_read_b128 v[220:223], v240 offset:10240
    buffer_load_dwordx4 v[32:35], v180, s[52:55], s62 offen offset:0 sc1
    v_rcp_f32 v237, v237
    v_mfma_f32_16x16x32_bf16 v[152:155], v[84:87], v[224:227], v[152:155]
    v_mul_f32 v142, v134, v142
    v_mul_f32 v239, v239, v135
    v_mfma_f32_16x16x32_bf16 v[148:151], v[80:83], v[228:231], v[148:151]
    ds_read_b128 v[224:227], v241 offset:8192
    v_mul_f32 v141, v141, v237
    v_add_f32 v238, 1.0, v238
    v_mfma_f32_16x16x32_bf16 v[156:159], v[84:87], v[228:231], v[156:159]
    v_exp_f32 v239, v239
    s_waitcnt lgkmcnt(3)
    v_mfma_f32_16x16x32_bf16 v[144:147], v[88:91], v[208:211], v[144:147]
    ds_read_b128 v[228:231], v241 offset:10240
    buffer_load_dwordx4 v[36:39], v180, s[52:55], s62 offen offset:256 sc1
    v_rcp_f32 v238, v238
    v_mfma_f32_16x16x32_bf16 v[152:155], v[92:95], v[208:211], v[152:155]
    v_mul_f32 v143, v135, v143
    v_cvt_pk_bf16_f32 v130, v140, v141
    v_mfma_f32_16x16x32_bf16 v[148:151], v[88:91], v[212:215], v[148:151]
    ds_read_b128 v[208:211], v240 offset:12288
    v_mul_f32 v142, v142, v238
    v_add_f32 v239, 1.0, v239
    v_mfma_f32_16x16x32_bf16 v[156:159], v[92:95], v[212:215], v[156:159]
    v_rcp_f32 v239, v239
    s_waitcnt lgkmcnt(3)
    v_mfma_f32_16x16x32_bf16 v[144:147], v[96:99], v[216:219], v[144:147]
    ds_read_b128 v[212:215], v240 offset:14336
    buffer_load_dwordx4 v[40:43], v180, s[52:55], s62 offen offset:2048 sc1
    v_mul_f32 v143, v143, v239
    v_cvt_pk_bf16_f32 v131, v142, v143
    v_mfma_f32_16x16x32_bf16 v[152:155], v[100:103], v[216:219], v[152:155]
    v_permlane16_swap_b32 v128, v130
    v_permlane16_swap_b32 v129, v131
    v_mfma_f32_16x16x32_bf16 v[148:151], v[96:99], v[220:223], v[148:151]
    ds_read_b128 v[216:219], v241 offset:12288
    buffer_store_dwordx4 v[128:131], v245, s[52:55], s82 offen sc1
    v_mfma_f32_16x16x32_bf16 v[156:159], v[100:103], v[220:223], v[156:159]
    s_waitcnt lgkmcnt(3)
    v_mfma_f32_16x16x32_bf16 v[144:147], v[104:107], v[224:227], v[144:147]
    ds_read_b128 v[220:223], v241 offset:14336
    buffer_load_dwordx4 v[44:47], v180, s[52:55], s62 offen offset:2304 sc1
    v_mfma_f32_16x16x32_bf16 v[152:155], v[108:111], v[224:227], v[152:155]
    v_mfma_f32_16x16x32_bf16 v[148:151], v[104:107], v[228:231], v[148:151]
    v_mfma_f32_16x16x32_bf16 v[156:159], v[108:111], v[228:231], v[156:159]
    s_waitcnt lgkmcnt(2)
    v_mfma_f32_16x16x32_bf16 v[144:147], v[112:115], v[208:211], v[144:147]
    v_mfma_f32_16x16x32_bf16 v[152:155], v[116:119], v[208:211], v[152:155]
    s_waitcnt lgkmcnt(0)
    s_barrier
    ds_read_b64_tr_b16 v[224:225], v176 offset:0
    ds_read_b64_tr_b16 v[226:227], v176 offset:512
    ds_read_b64_tr_b16 v[228:229], v177 offset:0
    ds_read_b64_tr_b16 v[230:231], v177 offset:512
    v_mfma_f32_16x16x32_bf16 v[148:151], v[112:115], v[212:215], v[148:151]
    ds_read_b64_tr_b16 v[208:209], v178 offset:0
    v_mfma_f32_16x16x32_bf16 v[156:159], v[116:119], v[212:215], v[156:159]
    ds_read_b64_tr_b16 v[210:211], v178 offset:512
    v_mfma_f32_16x16x32_bf16 v[144:147], v[120:123], v[216:219], v[144:147]
    ds_read_b64_tr_b16 v[212:213], v179 offset:0
    buffer_load_dwordx4 v[48:51], v180, s[52:55], s63 offen offset:0 sc1
    v_mfma_f32_16x16x32_bf16 v[152:155], v[124:127], v[216:219], v[152:155]
    ds_read_b64_tr_b16 v[214:215], v179 offset:512
    v_mfma_f32_16x16x32_bf16 v[148:151], v[120:123], v[220:223], v[148:151]
    ds_read_b64_tr_b16 v[216:217], v176 offset:4096
    v_mfma_f32_16x16x32_bf16 v[156:159], v[124:127], v[220:223], v[156:159]
    ds_read_b64_tr_b16 v[218:219], v176 offset:4608
    s_waitcnt vmcnt(12) lgkmcnt(6)
    v_mfma_f32_16x16x32_bf16 v[160:163], v[224:227], v[0:3], 0
    ds_read_b64_tr_b16 v[220:221], v177 offset:4096
    buffer_load_dwordx4 v[52:55], v180, s[52:55], s63 offen offset:256 sc1
    v_mfma_f32_16x16x32_bf16 v[164:167], v[224:227], v[4:7], 0
    ds_read_b64_tr_b16 v[222:223], v177 offset:4608
    v_mfma_f32_16x16x32_bf16 v[168:171], v[228:231], v[0:3], 0
    ds_read_b64_tr_b16 v[224:225], v178 offset:4096
    v_mfma_f32_16x16x32_bf16 v[172:175], v[228:231], v[4:7], 0
    ds_read_b64_tr_b16 v[226:227], v178 offset:4608
    s_waitcnt lgkmcnt(6)
    v_mfma_f32_16x16x32_bf16 v[128:131], v[208:211], v[0:3], 0
    ds_read_b64_tr_b16 v[228:229], v179 offset:4096
    buffer_load_dwordx4 v[56:59], v180, s[52:55], s63 offen offset:2048 sc1
    v_mfma_f32_16x16x32_bf16 v[132:135], v[208:211], v[4:7], 0
    ds_read_b64_tr_b16 v[230:231], v179 offset:4608
    v_mul_f32 v232, v144, v144
    v_fma_f32 v232, v232, s12, v246
    v_mul_f32 v232, v232, v144
    v_mul_f32 v233, v145, v145
    v_exp_f32 v232, v232
    v_fma_f32 v233, v233, s12, v246
    v_mul_f32 v152, v144, v152
    v_mul_f32 v233, v233, v145
    v_mul_f32 v234, v146, v146
    v_add_f32 v232, 1.0, v232
    v_exp_f32 v233, v233
    v_fma_f32 v234, v234, s12, v246
    v_rcp_f32 v232, v232
    v_mul_f32 v153, v145, v153
    v_mul_f32 v234, v234, v146
    v_mul_f32 v235, v147, v147
    v_mul_f32 v152, v152, v232
    v_add_f32 v233, 1.0, v233
    v_exp_f32 v234, v234
    v_fma_f32 v235, v235, s12, v246
    v_rcp_f32 v233, v233
    v_mul_f32 v154, v146, v154
    v_mul_f32 v235, v235, v147
    v_mul_f32 v236, v148, v148
    v_mul_f32 v153, v153, v233
    v_add_f32 v234, 1.0, v234
    v_exp_f32 v235, v235
    v_fma_f32 v236, v236, s12, v246
    v_rcp_f32 v234, v234
    v_mul_f32 v155, v147, v155
    v_mul_f32 v236, v236, v148
    v_mul_f32 v237, v149, v149
    v_cvt_pk_bf16_f32 v144, v152, v153
    v_mul_f32 v154, v154, v234
    v_add_f32 v235, 1.0, v235
    v_exp_f32 v236, v236
    v_fma_f32 v237, v237, s12, v246
    v_rcp_f32 v235, v235
    v_mul_f32 v156, v148, v156
    v_mul_f32 v237, v237, v149
    v_mul_f32 v238, v150, v150
    v_mul_f32 v155, v155, v235
    v_add_f32 v236, 1.0, v236
    v_exp_f32 v237, v237
    v_fma_f32 v238, v238, s12, v246
    v_rcp_f32 v236, v236
    v_mul_f32 v157, v149, v157
    v_mul_f32 v238, v238, v150
    v_mul_f32 v239, v151, v151
    v_cvt_pk_bf16_f32 v145, v154, v155
    v_mul_f32 v156, v156, v236
    v_add_f32 v237, 1.0, v237
    v_exp_f32 v238, v238
    v_fma_f32 v239, v239, s12, v246
    v_rcp_f32 v237, v237
    v_mul_f32 v158, v150, v158
    v_mul_f32 v239, v239, v151
    v_mul_f32 v157, v157, v237
    v_add_f32 v238, 1.0, v238
    v_exp_f32 v239, v239
    v_rcp_f32 v238, v238
    v_mul_f32 v159, v151, v159
    v_cvt_pk_bf16_f32 v146, v156, v157
    v_mul_f32 v158, v158, v238
    v_add_f32 v239, 1.0, v239
    v_rcp_f32 v239, v239
    s_nop 0
    v_mul_f32 v159, v159, v239
    v_cvt_pk_bf16_f32 v147, v158, v159
    v_permlane16_swap_b32 v144, v146
    s_nop 0
    v_permlane16_swap_b32 v145, v147
    buffer_store_dwordx4 v[144:147], v245, s[52:55], s83 offen sc1
    v_mfma_f32_16x16x32_bf16 v[136:139], v[212:215], v[0:3], 0
    v_add_u32 v176, 0x4000, v176
    ds_read_b64_tr_b16 v[208:209], v176 offset:0
    v_mfma_f32_16x16x32_bf16 v[140:143], v[212:215], v[4:7], 0
    ds_read_b64_tr_b16 v[210:211], v176 offset:512
    s_waitcnt vmcnt(13) lgkmcnt(6)
    v_mfma_f32_16x16x32_bf16 v[160:163], v[216:219], v[8:11], v[160:163]
    v_add_u32 v177, 0x4000, v177
    ds_read_b64_tr_b16 v[212:213], v177 offset:0
    buffer_load_dwordx4 v[60:63], v180, s[52:55], s63 offen offset:2304 sc1
    v_mfma_f32_16x16x32_bf16 v[164:167], v[216:219], v[12:15], v[164:167]
    ds_read_b64_tr_b16 v[214:215], v177 offset:512
    v_mfma_f32_16x16x32_bf16 v[168:171], v[220:223], v[8:11], v[168:171]
    v_add_u32 v178, 0x4000, v178
    ds_read_b64_tr_b16 v[216:217], v178 offset:0
    v_mfma_f32_16x16x32_bf16 v[172:175], v[220:223], v[12:15], v[172:175]
    ds_read_b64_tr_b16 v[218:219], v178 offset:512
    s_waitcnt lgkmcnt(6)
    v_mfma_f32_16x16x32_bf16 v[128:131], v[224:227], v[8:11], v[128:131]
    v_add_u32 v179, 0x4000, v179
    ds_read_b64_tr_b16 v[220:221], v179 offset:0
    buffer_load_dwordx4 v[64:67], v180, s[52:55], s64 offen offset:0 sc1
    v_mfma_f32_16x16x32_bf16 v[132:135], v[224:227], v[12:15], v[132:135]
    ds_read_b64_tr_b16 v[222:223], v179 offset:512
    v_mfma_f32_16x16x32_bf16 v[136:139], v[228:231], v[8:11], v[136:139]
    ds_read_b64_tr_b16 v[224:225], v176 offset:4096
    v_mfma_f32_16x16x32_bf16 v[140:143], v[228:231], v[12:15], v[140:143]
    ds_read_b64_tr_b16 v[226:227], v176 offset:4608
    s_waitcnt vmcnt(13) lgkmcnt(6)
    v_mfma_f32_16x16x32_bf16 v[160:163], v[208:211], v[16:19], v[160:163]
    ds_read_b64_tr_b16 v[228:229], v177 offset:4096
    buffer_load_dwordx4 v[68:71], v180, s[52:55], s64 offen offset:256 sc1
    v_mfma_f32_16x16x32_bf16 v[164:167], v[208:211], v[20:23], v[164:167]
    ds_read_b64_tr_b16 v[230:231], v177 offset:4608
    v_mfma_f32_16x16x32_bf16 v[168:171], v[212:215], v[16:19], v[168:171]
    ds_read_b64_tr_b16 v[208:209], v178 offset:4096
    v_mfma_f32_16x16x32_bf16 v[172:175], v[212:215], v[20:23], v[172:175]
    ds_read_b64_tr_b16 v[210:211], v178 offset:4608
    s_waitcnt lgkmcnt(6)
    v_mfma_f32_16x16x32_bf16 v[128:131], v[216:219], v[16:19], v[128:131]
    ds_read_b64_tr_b16 v[212:213], v179 offset:4096
    buffer_load_dwordx4 v[72:75], v180, s[52:55], s64 offen offset:2048 sc1
    v_mfma_f32_16x16x32_bf16 v[132:135], v[216:219], v[20:23], v[132:135]
    ds_read_b64_tr_b16 v[214:215], v179 offset:4608
    v_mfma_f32_16x16x32_bf16 v[136:139], v[220:223], v[16:19], v[136:139]
    v_add_u32 v176, 0x4000, v176
    ds_read_b64_tr_b16 v[216:217], v176 offset:0
    v_mfma_f32_16x16x32_bf16 v[140:143], v[220:223], v[20:23], v[140:143]
    ds_read_b64_tr_b16 v[218:219], v176 offset:512
    s_waitcnt vmcnt(13) lgkmcnt(6)
    v_mfma_f32_16x16x32_bf16 v[160:163], v[224:227], v[24:27], v[160:163]
    v_add_u32 v177, 0x4000, v177
    ds_read_b64_tr_b16 v[220:221], v177 offset:0
    buffer_load_dwordx4 v[76:79], v180, s[52:55], s64 offen offset:2304 sc1
    v_mfma_f32_16x16x32_bf16 v[164:167], v[224:227], v[28:31], v[164:167]
    ds_read_b64_tr_b16 v[222:223], v177 offset:512
    v_mfma_f32_16x16x32_bf16 v[168:171], v[228:231], v[24:27], v[168:171]
    v_add_u32 v178, 0x4000, v178
    ds_read_b64_tr_b16 v[224:225], v178 offset:0
    v_mfma_f32_16x16x32_bf16 v[172:175], v[228:231], v[28:31], v[172:175]
    ds_read_b64_tr_b16 v[226:227], v178 offset:512
    s_waitcnt lgkmcnt(6)
    v_mfma_f32_16x16x32_bf16 v[128:131], v[208:211], v[24:27], v[128:131]
    v_add_u32 v179, 0x4000, v179
    ds_read_b64_tr_b16 v[228:229], v179 offset:0
    v_mfma_f32_16x16x32_bf16 v[132:135], v[208:211], v[28:31], v[132:135]
    ds_read_b64_tr_b16 v[230:231], v179 offset:512
    v_mfma_f32_16x16x32_bf16 v[136:139], v[212:215], v[24:27], v[136:139]
    ds_read_b64_tr_b16 v[208:209], v176 offset:4096
    v_mfma_f32_16x16x32_bf16 v[140:143], v[212:215], v[28:31], v[140:143]
    ds_read_b64_tr_b16 v[210:211], v176 offset:4608
    s_waitcnt vmcnt(10)
    s_barrier
    s_waitcnt lgkmcnt(6)
    v_mfma_f32_16x16x32_bf16 v[160:163], v[216:219], v[32:35], v[160:163]
    ds_read_b64_tr_b16 v[212:213], v177 offset:4096
    v_mfma_f32_16x16x32_bf16 v[164:167], v[216:219], v[36:39], v[164:167]
    ds_read_b64_tr_b16 v[214:215], v177 offset:4608
    v_mfma_f32_16x16x32_bf16 v[168:171], v[220:223], v[32:35], v[168:171]
    ds_read_b64_tr_b16 v[216:217], v178 offset:4096
    buffer_load_dwordx4 v[80:83], v180, s[52:55], s65 offen offset:0 sc1
    v_mfma_f32_16x16x32_bf16 v[172:175], v[220:223], v[36:39], v[172:175]
    ds_read_b64_tr_b16 v[218:219], v178 offset:4608
    s_waitcnt lgkmcnt(6)
    v_mfma_f32_16x16x32_bf16 v[128:131], v[224:227], v[32:35], v[128:131]
    ds_read_b64_tr_b16 v[220:221], v179 offset:4096
    v_mfma_f32_16x16x32_bf16 v[132:135], v[224:227], v[36:39], v[132:135]
    ds_read_b64_tr_b16 v[222:223], v179 offset:4608
    v_mfma_f32_16x16x32_bf16 v[136:139], v[228:231], v[32:35], v[136:139]
    v_add_u32 v176, 0x4000, v176
    ds_read_b64_tr_b16 v[224:225], v176 offset:0
    buffer_load_dwordx4 v[84:87], v180, s[52:55], s65 offen offset:256 sc1
    v_mfma_f32_16x16x32_bf16 v[140:143], v[228:231], v[36:39], v[140:143]
    ds_read_b64_tr_b16 v[226:227], v176 offset:512
    s_waitcnt vmcnt(11) lgkmcnt(6)
    v_mfma_f32_16x16x32_bf16 v[160:163], v[208:211], v[40:43], v[160:163]
    v_add_u32 v177, 0x4000, v177
    ds_read_b64_tr_b16 v[228:229], v177 offset:0
    v_mfma_f32_16x16x32_bf16 v[164:167], v[208:211], v[44:47], v[164:167]
    ds_read_b64_tr_b16 v[230:231], v177 offset:512
    v_mfma_f32_16x16x32_bf16 v[168:171], v[212:215], v[40:43], v[168:171]
    v_add_u32 v178, 0x4000, v178
    ds_read_b64_tr_b16 v[208:209], v178 offset:0
    buffer_load_dwordx4 v[88:91], v180, s[52:55], s65 offen offset:2048 sc1
    v_mfma_f32_16x16x32_bf16 v[172:175], v[212:215], v[44:47], v[172:175]
    ds_read_b64_tr_b16 v[210:211], v178 offset:512
    s_waitcnt lgkmcnt(6)
    v_mfma_f32_16x16x32_bf16 v[128:131], v[216:219], v[40:43], v[128:131]
    v_add_u32 v179, 0x4000, v179
    ds_read_b64_tr_b16 v[212:213], v179 offset:0
    v_mfma_f32_16x16x32_bf16 v[132:135], v[216:219], v[44:47], v[132:135]
    ds_read_b64_tr_b16 v[214:215], v179 offset:512
    v_mfma_f32_16x16x32_bf16 v[136:139], v[220:223], v[40:43], v[136:139]
    ds_read_b64_tr_b16 v[216:217], v176 offset:4096
    buffer_load_dwordx4 v[92:95], v180, s[52:55], s65 offen offset:2304 sc1
    v_mfma_f32_16x16x32_bf16 v[140:143], v[220:223], v[44:47], v[140:143]
    ds_read_b64_tr_b16 v[218:219], v176 offset:4608
    s_waitcnt vmcnt(11) lgkmcnt(6)
    v_mfma_f32_16x16x32_bf16 v[160:163], v[224:227], v[48:51], v[160:163]
    ds_read_b64_tr_b16 v[220:221], v177 offset:4096
    v_mfma_f32_16x16x32_bf16 v[164:167], v[224:227], v[52:55], v[164:167]
    ds_read_b64_tr_b16 v[222:223], v177 offset:4608
    v_mfma_f32_16x16x32_bf16 v[168:171], v[228:231], v[48:51], v[168:171]
    ds_read_b64_tr_b16 v[224:225], v178 offset:4096
    buffer_load_dwordx4 v[96:99], v180, s[52:55], s66 offen offset:0 sc1
    v_mfma_f32_16x16x32_bf16 v[172:175], v[228:231], v[52:55], v[172:175]
    ds_read_b64_tr_b16 v[226:227], v178 offset:4608
    s_waitcnt lgkmcnt(6)
    v_mfma_f32_16x16x32_bf16 v[128:131], v[208:211], v[48:51], v[128:131]
    ds_read_b64_tr_b16 v[228:229], v179 offset:4096
    v_mfma_f32_16x16x32_bf16 v[132:135], v[208:211], v[52:55], v[132:135]
    ds_read_b64_tr_b16 v[230:231], v179 offset:4608
    v_mfma_f32_16x16x32_bf16 v[136:139], v[212:215], v[48:51], v[136:139]
    v_add_u32 v176, 0x8000, v176
    ds_read_b64_tr_b16 v[208:209], v176 offset:0
    buffer_load_dwordx4 v[100:103], v180, s[52:55], s66 offen offset:256 sc1
    v_mfma_f32_16x16x32_bf16 v[140:143], v[212:215], v[52:55], v[140:143]
    ds_read_b64_tr_b16 v[210:211], v176 offset:512
    s_waitcnt vmcnt(10) lgkmcnt(6)
    v_mfma_f32_16x16x32_bf16 v[160:163], v[216:219], v[56:59], v[160:163]
    v_add_u32 v177, 0x8000, v177
    ds_read_b64_tr_b16 v[212:213], v177 offset:0
    v_mfma_f32_16x16x32_bf16 v[164:167], v[216:219], v[60:63], v[164:167]
    ds_read_b64_tr_b16 v[214:215], v177 offset:512
    v_mfma_f32_16x16x32_bf16 v[168:171], v[220:223], v[56:59], v[168:171]
    v_add_u32 v178, 0x8000, v178
    ds_read_b64_tr_b16 v[216:217], v178 offset:0
    buffer_load_dwordx4 v[104:107], v180, s[52:55], s66 offen offset:2048 sc1
    v_mfma_f32_16x16x32_bf16 v[172:175], v[220:223], v[60:63], v[172:175]
    ds_read_b64_tr_b16 v[218:219], v178 offset:512
    s_waitcnt lgkmcnt(6)
    v_mfma_f32_16x16x32_bf16 v[128:131], v[224:227], v[56:59], v[128:131]
    v_add_u32 v179, 0x8000, v179
    ds_read_b64_tr_b16 v[220:221], v179 offset:0
    v_mfma_f32_16x16x32_bf16 v[132:135], v[224:227], v[60:63], v[132:135]
    ds_read_b64_tr_b16 v[222:223], v179 offset:512
    v_mfma_f32_16x16x32_bf16 v[136:139], v[228:231], v[56:59], v[136:139]
    ds_read_b64_tr_b16 v[224:225], v176 offset:4096
    buffer_load_dwordx4 v[108:111], v180, s[52:55], s66 offen offset:2304 sc1
    v_mfma_f32_16x16x32_bf16 v[140:143], v[228:231], v[60:63], v[140:143]
    ds_read_b64_tr_b16 v[226:227], v176 offset:4608
    s_barrier
    s_waitcnt vmcnt(10) lgkmcnt(6)
    v_mfma_f32_16x16x32_bf16 v[160:163], v[208:211], v[64:67], v[160:163]
    ds_read_b64_tr_b16 v[228:229], v177 offset:4096
    v_mfma_f32_16x16x32_bf16 v[164:167], v[208:211], v[68:71], v[164:167]
    ds_read_b64_tr_b16 v[230:231], v177 offset:4608
    v_mfma_f32_16x16x32_bf16 v[168:171], v[212:215], v[64:67], v[168:171]
    ds_read_b64_tr_b16 v[208:209], v178 offset:4096
    buffer_load_dwordx4 v[112:115], v180, s[52:55], s67 offen offset:0 sc1
    v_mfma_f32_16x16x32_bf16 v[172:175], v[212:215], v[68:71], v[172:175]
    ds_read_b64_tr_b16 v[210:211], v178 offset:4608
    s_waitcnt lgkmcnt(6)
    v_mfma_f32_16x16x32_bf16 v[128:131], v[216:219], v[64:67], v[128:131]
    ds_read_b64_tr_b16 v[212:213], v179 offset:4096
    v_mfma_f32_16x16x32_bf16 v[132:135], v[216:219], v[68:71], v[132:135]
    ds_read_b64_tr_b16 v[214:215], v179 offset:4608
    v_mfma_f32_16x16x32_bf16 v[136:139], v[220:223], v[64:67], v[136:139]
    v_add_u32 v176, 0xffffc000, v176
    ds_read_b64_tr_b16 v[216:217], v176 offset:0
    buffer_load_dwordx4 v[116:119], v180, s[52:55], s67 offen offset:256 sc1
    v_mfma_f32_16x16x32_bf16 v[140:143], v[220:223], v[68:71], v[140:143]
    ds_read_b64_tr_b16 v[218:219], v176 offset:512
    s_waitcnt vmcnt(10) lgkmcnt(6)
    v_mfma_f32_16x16x32_bf16 v[160:163], v[224:227], v[72:75], v[160:163]
    v_add_u32 v177, 0xffffc000, v177
    ds_read_b64_tr_b16 v[220:221], v177 offset:0
    v_mfma_f32_16x16x32_bf16 v[164:167], v[224:227], v[76:79], v[164:167]
    ds_read_b64_tr_b16 v[222:223], v177 offset:512
    v_mfma_f32_16x16x32_bf16 v[168:171], v[228:231], v[72:75], v[168:171]
    v_add_u32 v178, 0xffffc000, v178
    ds_read_b64_tr_b16 v[224:225], v178 offset:0
    buffer_load_dwordx4 v[120:123], v180, s[52:55], s67 offen offset:2048 sc1
    v_mfma_f32_16x16x32_bf16 v[172:175], v[228:231], v[76:79], v[172:175]
    ds_read_b64_tr_b16 v[226:227], v178 offset:512
    s_waitcnt lgkmcnt(6)
    v_mfma_f32_16x16x32_bf16 v[128:131], v[208:211], v[72:75], v[128:131]
    v_add_u32 v179, 0xffffc000, v179
    ds_read_b64_tr_b16 v[228:229], v179 offset:0
    v_mfma_f32_16x16x32_bf16 v[132:135], v[208:211], v[76:79], v[132:135]
    ds_read_b64_tr_b16 v[230:231], v179 offset:512
    v_mfma_f32_16x16x32_bf16 v[136:139], v[212:215], v[72:75], v[136:139]
    ds_read_b64_tr_b16 v[208:209], v176 offset:4096
    buffer_load_dwordx4 v[124:127], v180, s[52:55], s67 offen offset:2304 sc1
    v_mfma_f32_16x16x32_bf16 v[140:143], v[212:215], v[76:79], v[140:143]
    ds_read_b64_tr_b16 v[210:211], v176 offset:4608
    s_waitcnt vmcnt(10) lgkmcnt(6)
    v_mfma_f32_16x16x32_bf16 v[160:163], v[216:219], v[80:83], v[160:163]
    ds_read_b64_tr_b16 v[212:213], v177 offset:4096
    v_mfma_f32_16x16x32_bf16 v[164:167], v[216:219], v[84:87], v[164:167]
    ds_read_b64_tr_b16 v[214:215], v177 offset:4608
    v_mfma_f32_16x16x32_bf16 v[168:171], v[220:223], v[80:83], v[168:171]
    ds_read_b64_tr_b16 v[216:217], v178 offset:4096
    buffer_load_dwordx4 v[0:3], v180, s[52:55], s68 offen offset:0 sc1
    v_mfma_f32_16x16x32_bf16 v[172:175], v[220:223], v[84:87], v[172:175]
    ds_read_b64_tr_b16 v[218:219], v178 offset:4608
    s_waitcnt lgkmcnt(6)
    v_mfma_f32_16x16x32_bf16 v[128:131], v[224:227], v[80:83], v[128:131]
    ds_read_b64_tr_b16 v[220:221], v179 offset:4096
    v_mfma_f32_16x16x32_bf16 v[132:135], v[224:227], v[84:87], v[132:135]
    ds_read_b64_tr_b16 v[222:223], v179 offset:4608
    v_mfma_f32_16x16x32_bf16 v[136:139], v[228:231], v[80:83], v[136:139]
    v_add_u32 v176, 0x8000, v176
    ds_read_b64_tr_b16 v[224:225], v176 offset:0
    buffer_load_dwordx4 v[4:7], v180, s[52:55], s68 offen offset:256 sc1
    v_mfma_f32_16x16x32_bf16 v[140:143], v[228:231], v[84:87], v[140:143]
    ds_read_b64_tr_b16 v[226:227], v176 offset:512
    s_waitcnt vmcnt(10) lgkmcnt(6)
    v_mfma_f32_16x16x32_bf16 v[160:163], v[208:211], v[88:91], v[160:163]
    v_add_u32 v177, 0x8000, v177
    ds_read_b64_tr_b16 v[228:229], v177 offset:0
    v_mfma_f32_16x16x32_bf16 v[164:167], v[208:211], v[92:95], v[164:167]
    ds_read_b64_tr_b16 v[230:231], v177 offset:512
    v_mfma_f32_16x16x32_bf16 v[168:171], v[212:215], v[88:91], v[168:171]
    v_add_u32 v178, 0x8000, v178
    ds_read_b64_tr_b16 v[208:209], v178 offset:0
    buffer_load_dwordx4 v[8:11], v180, s[52:55], s68 offen offset:2048 sc1
    v_mfma_f32_16x16x32_bf16 v[172:175], v[212:215], v[92:95], v[172:175]
    ds_read_b64_tr_b16 v[210:211], v178 offset:512
    s_waitcnt lgkmcnt(6)
    v_mfma_f32_16x16x32_bf16 v[128:131], v[216:219], v[88:91], v[128:131]
    v_add_u32 v179, 0x8000, v179
    ds_read_b64_tr_b16 v[212:213], v179 offset:0
    v_mfma_f32_16x16x32_bf16 v[132:135], v[216:219], v[92:95], v[132:135]
    ds_read_b64_tr_b16 v[214:215], v179 offset:512
    v_mfma_f32_16x16x32_bf16 v[136:139], v[220:223], v[88:91], v[136:139]
    ds_read_b64_tr_b16 v[216:217], v176 offset:4096
    buffer_load_dwordx4 v[12:15], v180, s[52:55], s68 offen offset:2304 sc1
    v_mfma_f32_16x16x32_bf16 v[140:143], v[220:223], v[92:95], v[140:143]
    ds_read_b64_tr_b16 v[218:219], v176 offset:4608
    s_branch L_pg3
.p2align 12
L_stub3:
    s_setpc_b64 s[98:99]
L_pg3:
    s_barrier
    s_waitcnt vmcnt(10) lgkmcnt(6)
    v_mfma_f32_16x16x32_bf16 v[160:163], v[224:227], v[96:99], v[160:163]
    ds_read_b64_tr_b16 v[220:221], v177 offset:4096
    v_mfma_f32_16x16x32_bf16 v[164:167], v[224:227], v[100:103], v[164:167]
    ds_read_b64_tr_b16 v[222:223], v177 offset:4608
    v_mfma_f32_16x16x32_bf16 v[168:171], v[228:231], v[96:99], v[168:171]
    ds_read_b64_tr_b16 v[224:225], v178 offset:4096
    buffer_load_dwordx4 v[16:19], v180, s[52:55], s69 offen offset:0 sc1
    v_mfma_f32_16x16x32_bf16 v[172:175], v[228:231], v[100:103], v[172:175]
    ds_read_b64_tr_b16 v[226:227], v178 offset:4608
    s_waitcnt lgkmcnt(6)
    v_mfma_f32_16x16x32_bf16 v[128:131], v[208:211], v[96:99], v[128:131]
    ds_read_b64_tr_b16 v[228:229], v179 offset:4096
    v_mfma_f32_16x16x32_bf16 v[132:135], v[208:211], v[100:103], v[132:135]
    ds_read_b64_tr_b16 v[230:231], v179 offset:4608
    v_mfma_f32_16x16x32_bf16 v[136:139], v[212:215], v[96:99], v[136:139]
    v_add_u32 v176, 0xfffe0000, v176
    ds_read_b64_tr_b16 v[208:209], v176 offset:0
    buffer_load_dwordx4 v[20:23], v180, s[52:55], s69 offen offset:256 sc1
    v_mfma_f32_16x16x32_bf16 v[140:143], v[212:215], v[100:103], v[140:143]
    ds_read_b64_tr_b16 v[210:211], v176 offset:512
    s_waitcnt vmcnt(10) lgkmcnt(6)
    v_mfma_f32_16x16x32_bf16 v[160:163], v[216:219], v[104:107], v[160:163]
    v_add_u32 v177, 0xfffe0000, v177
    ds_read_b64_tr_b16 v[212:213], v177 offset:0
    v_mfma_f32_16x16x32_bf16 v[164:167], v[216:219], v[108:111], v[164:167]
    ds_read_b64_tr_b16 v[214:215], v177 offset:512
    v_mfma_f32_16x16x32_bf16 v[168:171], v[220:223], v[104:107], v[168:171]
    v_add_u32 v178, 0xfffe0000, v178
    ds_read_b64_tr_b16 v[216:217], v178 offset:0
    buffer_load_dwordx4 v[24:27], v180, s[52:55], s69 offen offset:2048 sc1
    v_mfma_f32_16x16x32_bf16 v[172:175], v[220:223], v[108:111], v[172:175]
    ds_read_b64_tr_b16 v[218:219], v178 offset:512
    s_waitcnt lgkmcnt(6)
    v_mfma_f32_16x16x32_bf16 v[128:131], v[224:227], v[104:107], v[128:131]
    v_add_u32 v179, 0xfffe0000, v179
    ds_read_b64_tr_b16 v[220:221], v179 offset:0
    v_mfma_f32_16x16x32_bf16 v[132:135], v[224:227], v[108:111], v[132:135]
    ds_read_b64_tr_b16 v[222:223], v179 offset:512
    v_mfma_f32_16x16x32_bf16 v[136:139], v[228:231], v[104:107], v[136:139]
    ds_read_b64_tr_b16 v[224:225], v176 offset:4096
    buffer_load_dwordx4 v[28:31], v180, s[52:55], s69 offen offset:2304 sc1
    v_mfma_f32_16x16x32_bf16 v[140:143], v[228:231], v[108:111], v[140:143]
    ds_read_b64_tr_b16 v[226:227], v176 offset:4608
    s_waitcnt vmcnt(10) lgkmcnt(6)
    v_mfma_f32_16x16x32_bf16 v[160:163], v[208:211], v[112:115], v[160:163]
    ds_read_b64_tr_b16 v[228:229], v177 offset:4096
    v_mfma_f32_16x16x32_bf16 v[164:167], v[208:211], v[116:119], v[164:167]
    ds_read_b64_tr_b16 v[230:231], v177 offset:4608
    v_mfma_f32_16x16x32_bf16 v[168:171], v[212:215], v[112:115], v[168:171]
    ds_read_b64_tr_b16 v[208:209], v178 offset:4096
    v_mfma_f32_16x16x32_bf16 v[172:175], v[212:215], v[116:119], v[172:175]
    ds_read_b64_tr_b16 v[210:211], v178 offset:4608
    s_waitcnt lgkmcnt(6)
    v_mfma_f32_16x16x32_bf16 v[128:131], v[216:219], v[112:115], v[128:131]
    ds_read_b64_tr_b16 v[212:213], v179 offset:4096
    v_mfma_f32_16x16x32_bf16 v[132:135], v[216:219], v[116:119], v[132:135]
    ds_read_b64_tr_b16 v[214:215], v179 offset:4608
    v_mfma_f32_16x16x32_bf16 v[136:139], v[220:223], v[112:115], v[136:139]
    v_add_u32 v176, 0x4000, v176
    ds_read_b64_tr_b16 v[216:217], v176 offset:0
    v_mfma_f32_16x16x32_bf16 v[140:143], v[220:223], v[116:119], v[140:143]
    ds_read_b64_tr_b16 v[218:219], v176 offset:512
    s_waitcnt vmcnt(8) lgkmcnt(6)
    v_mfma_f32_16x16x32_bf16 v[160:163], v[224:227], v[120:123], v[160:163]
    v_add_u32 v177, 0x4000, v177
    ds_read_b64_tr_b16 v[220:221], v177 offset:0
    v_mfma_f32_16x16x32_bf16 v[164:167], v[224:227], v[124:127], v[164:167]
    ds_read_b64_tr_b16 v[222:223], v177 offset:512
    v_mfma_f32_16x16x32_bf16 v[168:171], v[228:231], v[120:123], v[168:171]
    v_add_u32 v178, 0x4000, v178
    ds_read_b64_tr_b16 v[224:225], v178 offset:0
    v_mfma_f32_16x16x32_bf16 v[172:175], v[228:231], v[124:127], v[172:175]
    ds_read_b64_tr_b16 v[226:227], v178 offset:512
    s_waitcnt lgkmcnt(6)
    v_mfma_f32_16x16x32_bf16 v[128:131], v[208:211], v[120:123], v[128:131]
    v_add_u32 v179, 0x4000, v179
    ds_read_b64_tr_b16 v[228:229], v179 offset:0
    v_mfma_f32_16x16x32_bf16 v[132:135], v[208:211], v[124:127], v[132:135]
    ds_read_b64_tr_b16 v[230:231], v179 offset:512
    v_mfma_f32_16x16x32_bf16 v[136:139], v[212:215], v[120:123], v[136:139]
    ds_read_b64_tr_b16 v[208:209], v176 offset:4096
    v_mfma_f32_16x16x32_bf16 v[140:143], v[212:215], v[124:127], v[140:143]
    ds_read_b64_tr_b16 v[210:211], v176 offset:4608
    s_barrier
    s_waitcnt vmcnt(6) lgkmcnt(6)
    v_mfma_f32_16x16x32_bf16 v[160:163], v[216:219], v[0:3], v[160:163]
    ds_read_b64_tr_b16 v[212:213], v177 offset:4096
    buffer_load_dwordx4 v[32:35], v180, s[52:55], s70 offen offset:0 sc1
    v_mfma_f32_16x16x32_bf16 v[164:167], v[216:219], v[4:7], v[164:167]
    ds_read_b64_tr_b16 v[214:215], v177 offset:4608
    v_mfma_f32_16x16x32_bf16 v[168:171], v[220:223], v[0:3], v[168:171]
    ds_read_b64_tr_b16 v[216:217], v178 offset:4096
    buffer_load_dwordx4 v[36:39], v180, s[52:55], s70 offen offset:256 sc1
    v_mfma_f32_16x16x32_bf16 v[172:175], v[220:223], v[4:7], v[172:175]
    ds_read_b64_tr_b16 v[218:219], v178 offset:4608
    s_waitcnt lgkmcnt(6)
    v_mfma_f32_16x16x32_bf16 v[128:131], v[224:227], v[0:3], v[128:131]
    ds_read_b64_tr_b16 v[220:221], v179 offset:4096
    buffer_load_dwordx4 v[40:43], v180, s[52:55], s70 offen offset:2048 sc1
    v_mfma_f32_16x16x32_bf16 v[132:135], v[224:227], v[4:7], v[132:135]
    ds_read_b64_tr_b16 v[222:223], v179 offset:4608
    v_mfma_f32_16x16x32_bf16 v[136:139], v[228:231], v[0:3], v[136:139]
    v_add_u32 v176, 0xffff8000, v176
    ds_read_b64_tr_b16 v[224:225], v176 offset:0
    buffer_load_dwordx4 v[44:47], v180, s[52:55], s70 offen offset:2304 sc1
    v_mfma_f32_16x16x32_bf16 v[140:143], v[228:231], v[4:7], v[140:143]
    ds_read_b64_tr_b16 v[226:227], v176 offset:512
    s_waitcnt vmcnt(8) lgkmcnt(6)
    v_mfma_f32_16x16x32_bf16 v[160:163], v[208:211], v[8:11], v[160:163]
    v_add_u32 v177, 0xffff8000, v177
    ds_read_b64_tr_b16 v[228:229], v177 offset:0
    buffer_load_dwordx4 v[48:51], v180, s[52:55], s71 offen offset:0 sc1
    v_mfma_f32_16x16x32_bf16 v[164:167], v[208:211], v[12:15], v[164:167]
    ds_read_b64_tr_b16 v[230:231], v177 offset:512
    v_mfma_f32_16x16x32_bf16 v[168:171], v[212:215], v[8:11], v[168:171]
    v_add_u32 v178, 0xffff8000, v178
    ds_read_b64_tr_b16 v[208:209], v178 offset:0
    buffer_load_dwordx4 v[52:55], v180, s[52:55], s71 offen offset:256 sc1
    v_mfma_f32_16x16x32_bf16 v[172:175], v[212:215], v[12:15], v[172:175]
    ds_read_b64_tr_b16 v[210:211], v178 offset:512
    s_waitcnt lgkmcnt(6)
    v_mfma_f32_16x16x32_bf16 v[128:131], v[216:219], v[8:11], v[128:131]
    v_add_u32 v179, 0xffff8000, v179
    ds_read_b64_tr_b16 v[212:213], v179 offset:0
    buffer_load_dwordx4 v[56:59], v180, s[52:55], s71 offen offset:2048 sc1
    v_mfma_f32_16x16x32_bf16 v[132:135], v[216:219], v[12:15], v[132:135]
    ds_read_b64_tr_b16 v[214:215], v179 offset:512
    v_mfma_f32_16x16x32_bf16 v[136:139], v[220:223], v[8:11], v[136:139]
    ds_read_b64_tr_b16 v[216:217], v176 offset:4096
    buffer_load_dwordx4 v[60:63], v180, s[52:55], s71 offen offset:2304 sc1
    v_mfma_f32_16x16x32_bf16 v[140:143], v[220:223], v[12:15], v[140:143]
    ds_read_b64_tr_b16 v[218:219], v176 offset:4608
    s_waitcnt vmcnt(10) lgkmcnt(6)
    v_mfma_f32_16x16x32_bf16 v[160:163], v[224:227], v[16:19], v[160:163]
    ds_read_b64_tr_b16 v[220:221], v177 offset:4096
    v_mfma_f32_16x16x32_bf16 v[164:167], v[224:227], v[20:23], v[164:167]
    ds_read_b64_tr_b16 v[222:223], v177 offset:4608
    v_mfma_f32_16x16x32_bf16 v[168:171], v[228:231], v[16:19], v[168:171]
    ds_read_b64_tr_b16 v[224:225], v178 offset:4096
    v_mfma_f32_16x16x32_bf16 v[172:175], v[228:231], v[20:23], v[172:175]
    ds_read_b64_tr_b16 v[226:227], v178 offset:4608
    s_waitcnt lgkmcnt(6)
    v_mfma_f32_16x16x32_bf16 v[128:131], v[208:211], v[16:19], v[128:131]
    ds_read_b64_tr_b16 v[228:229], v179 offset:4096
    v_mfma_f32_16x16x32_bf16 v[132:135], v[208:211], v[20:23], v[132:135]
    ds_read_b64_tr_b16 v[230:231], v179 offset:4608
    v_mfma_f32_16x16x32_bf16 v[136:139], v[212:215], v[16:19], v[136:139]
    v_add_u32 v176, s88, v176
    ds_read_b64_tr_b16 v[208:209], v176 offset:0
    v_mfma_f32_16x16x32_bf16 v[140:143], v[212:215], v[20:23], v[140:143]
    ds_read_b64_tr_b16 v[210:211], v176 offset:512
    s_waitcnt vmcnt(8) lgkmcnt(6)
    v_mfma_f32_16x16x32_bf16 v[160:163], v[216:219], v[24:27], v[160:163]
    v_add_u32 v177, s88, v177
    ds_read_b64_tr_b16 v[212:213], v177 offset:0
    v_mfma_f32_16x16x32_bf16 v[164:167], v[216:219], v[28:31], v[164:167]
    ds_read_b64_tr_b16 v[214:215], v177 offset:512
    v_mfma_f32_16x16x32_bf16 v[168:171], v[220:223], v[24:27], v[168:171]
    v_add_u32 v178, s88, v178
    ds_read_b64_tr_b16 v[216:217], v178 offset:0
    v_mfma_f32_16x16x32_bf16 v[172:175], v[220:223], v[28:31], v[172:175]
    ds_read_b64_tr_b16 v[218:219], v178 offset:512
    s_waitcnt lgkmcnt(6)
    v_mfma_f32_16x16x32_bf16 v[128:131], v[224:227], v[24:27], v[128:131]
    v_add_u32 v179, s88, v179
    ds_read_b64_tr_b16 v[220:221], v179 offset:0
    v_mfma_f32_16x16x32_bf16 v[132:135], v[224:227], v[28:31], v[132:135]
    ds_read_b64_tr_b16 v[222:223], v179 offset:512
    v_mfma_f32_16x16x32_bf16 v[136:139], v[228:231], v[24:27], v[136:139]
    ds_read_b64_tr_b16 v[224:225], v176 offset:4096
    v_mfma_f32_16x16x32_bf16 v[140:143], v[228:231], v[28:31], v[140:143]
    ds_read_b64_tr_b16 v[226:227], v176 offset:4608
    s_barrier
    s_waitcnt vmcnt(6) lgkmcnt(6)
    v_mfma_f32_16x16x32_bf16 v[160:163], v[208:211], v[32:35], v[160:163]
    ds_read_b64_tr_b16 v[228:229], v177 offset:4096
    buffer_load_dwordx4 v[64:67], v180, s[52:55], s72 offen offset:0 sc1
    v_mfma_f32_16x16x32_bf16 v[164:167], v[208:211], v[36:39], v[164:167]
    ds_read_b64_tr_b16 v[230:231], v177 offset:4608
    v_mfma_f32_16x16x32_bf16 v[168:171], v[212:215], v[32:35], v[168:171]
    ds_read_b64_tr_b16 v[208:209], v178 offset:4096
    buffer_load_dwordx4 v[68:71], v180, s[52:55], s72 offen offset:256 sc1
    v_mfma_f32_16x16x32_bf16 v[172:175], v[212:215], v[36:39], v[172:175]
    ds_read_b64_tr_b16 v[210:211], v178 offset:4608
    s_waitcnt lgkmcnt(6)
    v_mfma_f32_16x16x32_bf16 v[128:131], v[216:219], v[32:35], v[128:131]
    ds_read_b64_tr_b16 v[212:213], v179 offset:4096
    buffer_load_dwordx4 v[72:75], v180, s[52:55], s72 offen offset:2048 sc1
    v_mfma_f32_16x16x32_bf16 v[132:135], v[216:219], v[36:39], v[132:135]
    ds_read_b64_tr_b16 v[214:215], v179 offset:4608
    v_mfma_f32_16x16x32_bf16 v[136:139], v[220:223], v[32:35], v[136:139]
    v_add_u32 v176, s89, v176
    ds_read_b64_tr_b16 v[216:217], v176 offset:0
    buffer_load_dwordx4 v[76:79], v180, s[52:55], s72 offen offset:2304 sc1
    v_mfma_f32_16x16x32_bf16 v[140:143], v[220:223], v[36:39], v[140:143]
    ds_read_b64_tr_b16 v[218:219], v176 offset:512
    s_waitcnt vmcnt(8) lgkmcnt(6)
    v_mfma_f32_16x16x32_bf16 v[160:163], v[224:227], v[40:43], v[160:163]
    v_add_u32 v177, s89, v177
    ds_read_b64_tr_b16 v[220:221], v177 offset:0
    buffer_load_dwordx4 v[80:83], v180, s[52:55], s73 offen offset:0 sc1
    v_mfma_f32_16x16x32_bf16 v[164:167], v[224:227], v[44:47], v[164:167]
    ds_read_b64_tr_b16 v[222:223], v177 offset:512
    v_mfma_f32_16x16x32_bf16 v[168:171], v[228:231], v[40:43], v[168:171]
    v_add_u32 v178, s89, v178
    ds_read_b64_tr_b16 v[224:225], v178 offset:0
    buffer_load_dwordx4 v[84:87], v180, s[52:55], s73 offen offset:256 sc1
    v_mfma_f32_16x16x32_bf16 v[172:175], v[228:231], v[44:47], v[172:175]
    ds_read_b64_tr_b16 v[226:227], v178 offset:512
    s_waitcnt lgkmcnt(6)
    v_mfma_f32_16x16x32_bf16 v[128:131], v[208:211], v[40:43], v[128:131]
    v_add_u32 v179, s89, v179
    ds_read_b64_tr_b16 v[228:229], v179 offset:0
    buffer_load_dwordx4 v[88:91], v180, s[52:55], s73 offen offset:2048 sc1
    v_mfma_f32_16x16x32_bf16 v[132:135], v[208:211], v[44:47], v[132:135]
    ds_read_b64_tr_b16 v[230:231], v179 offset:512
    v_mfma_f32_16x16x32_bf16 v[136:139], v[212:215], v[40:43], v[136:139]
    ds_read_b64_tr_b16 v[208:209], v176 offset:4096
    buffer_load_dwordx4 v[92:95], v180, s[52:55], s73 offen offset:2304 sc1
    v_mfma_f32_16x16x32_bf16 v[140:143], v[212:215], v[44:47], v[140:143]
    ds_read_b64_tr_b16 v[210:211], v176 offset:4608
    s_waitcnt vmcnt(10) lgkmcnt(6)
    v_mfma_f32_16x16x32_bf16 v[160:163], v[216:219], v[48:51], v[160:163]
    ds_read_b64_tr_b16 v[212:213], v177 offset:4096
    v_mfma_f32_16x16x32_bf16 v[164:167], v[216:219], v[52:55], v[164:167]
    ds_read_b64_tr_b16 v[214:215], v177 offset:4608
    v_mfma_f32_16x16x32_bf16 v[168:171], v[220:223], v[48:51], v[168:171]
    ds_read_b64_tr_b16 v[216:217], v178 offset:4096
    v_mfma_f32_16x16x32_bf16 v[172:175], v[220:223], v[52:55], v[172:175]
    ds_read_b64_tr_b16 v[218:219], v178 offset:4608
    s_waitcnt lgkmcnt(6)
    v_mfma_f32_16x16x32_bf16 v[128:131], v[224:227], v[48:51], v[128:131]
    ds_read_b64_tr_b16 v[220:221], v179 offset:4096
    v_mfma_f32_16x16x32_bf16 v[132:135], v[224:227], v[52:55], v[132:135]
    ds_read_b64_tr_b16 v[222:223], v179 offset:4608
    v_mfma_f32_16x16x32_bf16 v[136:139], v[228:231], v[48:51], v[136:139]
    v_add_u32 v176, s90, v176
    ds_read_b64_tr_b16 v[224:225], v176 offset:0
    v_mfma_f32_16x16x32_bf16 v[140:143], v[228:231], v[52:55], v[140:143]
    ds_read_b64_tr_b16 v[226:227], v176 offset:512
    s_waitcnt vmcnt(8) lgkmcnt(6)
    v_mfma_f32_16x16x32_bf16 v[160:163], v[208:211], v[56:59], v[160:163]
    v_add_u32 v177, s90, v177
    ds_read_b64_tr_b16 v[228:229], v177 offset:0
    v_mfma_f32_16x16x32_bf16 v[164:167], v[208:211], v[60:63], v[164:167]
    ds_read_b64_tr_b16 v[230:231], v177 offset:512
    v_mfma_f32_16x16x32_bf16 v[168:171], v[212:215], v[56:59], v[168:171]
    v_add_u32 v178, s90, v178
    ds_read_b64_tr_b16 v[208:209], v178 offset:0
    v_mfma_f32_16x16x32_bf16 v[172:175], v[212:215], v[60:63], v[172:175]
    ds_read_b64_tr_b16 v[210:211], v178 offset:512
    s_waitcnt lgkmcnt(6)
    v_mfma_f32_16x16x32_bf16 v[128:131], v[216:219], v[56:59], v[128:131]
    v_add_u32 v179, s90, v179
    ds_read_b64_tr_b16 v[212:213], v179 offset:0
    v_mfma_f32_16x16x32_bf16 v[132:135], v[216:219], v[60:63], v[132:135]
    ds_read_b64_tr_b16 v[214:215], v179 offset:512
    v_mfma_f32_16x16x32_bf16 v[136:139], v[220:223], v[56:59], v[136:139]
    ds_read_b64_tr_b16 v[216:217], v176 offset:4096
    v_mfma_f32_16x16x32_bf16 v[140:143], v[220:223], v[60:63], v[140:143]
    ds_read_b64_tr_b16 v[218:219], v176 offset:4608
    s_waitcnt vmcnt(6) lgkmcnt(6)
    v_mfma_f32_16x16x32_bf16 v[160:163], v[224:227], v[64:67], v[160:163]
    ds_read_b64_tr_b16 v[220:221], v177 offset:4096
    v_mfma_f32_16x16x32_bf16 v[164:167], v[224:227], v[68:71], v[164:167]
    ds_read_b64_tr_b16 v[222:223], v177 offset:4608
    v_mfma_f32_16x16x32_bf16 v[168:171], v[228:231], v[64:67], v[168:171]
    ds_read_b64_tr_b16 v[224:225], v178 offset:4096
    v_mfma_f32_16x16x32_bf16 v[172:175], v[228:231], v[68:71], v[172:175]
    ds_read_b64_tr_b16 v[226:227], v178 offset:4608
    s_waitcnt lgkmcnt(6)
    v_mfma_f32_16x16x32_bf16 v[128:131], v[208:211], v[64:67], v[128:131]
    ds_read_b64_tr_b16 v[228:229], v179 offset:4096
    v_mfma_f32_16x16x32_bf16 v[132:135], v[208:211], v[68:71], v[132:135]
    ds_read_b64_tr_b16 v[230:231], v179 offset:4608
    v_mfma_f32_16x16x32_bf16 v[136:139], v[212:215], v[64:67], v[136:139]
    v_add_u32 v176, s91, v176
    ds_read_b64_tr_b16 v[208:209], v176 offset:0
    v_mfma_f32_16x16x32_bf16 v[140:143], v[212:215], v[68:71], v[140:143]
    ds_read_b64_tr_b16 v[210:211], v176 offset:512
    s_waitcnt vmcnt(4) lgkmcnt(6)
    v_mfma_f32_16x16x32_bf16 v[160:163], v[216:219], v[72:75], v[160:163]
    v_add_u32 v177, s91, v177
    ds_read_b64_tr_b16 v[212:213], v177 offset:0
    v_mfma_f32_16x16x32_bf16 v[164:167], v[216:219], v[76:79], v[164:167]
    ds_read_b64_tr_b16 v[214:215], v177 offset:512
    v_mfma_f32_16x16x32_bf16 v[168:171], v[220:223], v[72:75], v[168:171]
    ds_read_b64_tr_b16 v[216:217], v176 offset:4096
    v_mfma_f32_16x16x32_bf16 v[172:175], v[220:223], v[76:79], v[172:175]
    ds_read_b64_tr_b16 v[218:219], v176 offset:4608
    s_waitcnt lgkmcnt(6)
    v_mfma_f32_16x16x32_bf16 v[128:131], v[224:227], v[72:75], v[128:131]
    ds_read_b64_tr_b16 v[220:221], v177 offset:4096
    v_mfma_f32_16x16x32_bf16 v[132:135], v[224:227], v[76:79], v[132:135]
    ds_read_b64_tr_b16 v[222:223], v177 offset:4608
    v_mfma_f32_16x16x32_bf16 v[136:139], v[228:231], v[72:75], v[136:139]
    v_add_u32 v178, s91, v178
    ds_read_b64_tr_b16 v[224:225], v178 offset:0
    v_mfma_f32_16x16x32_bf16 v[140:143], v[228:231], v[76:79], v[140:143]
    ds_read_b64_tr_b16 v[226:227], v178 offset:512
    s_waitcnt vmcnt(2) lgkmcnt(6)
    v_mfma_f32_16x16x32_bf16 v[160:163], v[208:211], v[80:83], v[160:163]
    v_add_u32 v179, s91, v179
    ds_read_b64_tr_b16 v[228:229], v179 offset:0
    v_mfma_f32_16x16x32_bf16 v[164:167], v[208:211], v[84:87], v[164:167]
    ds_read_b64_tr_b16 v[230:231], v179 offset:512
    v_mfma_f32_16x16x32_bf16 v[168:171], v[212:215], v[80:83], v[168:171]
    ds_read_b64_tr_b16 v[208:209], v178 offset:4096
    v_mfma_f32_16x16x32_bf16 v[172:175], v[212:215], v[84:87], v[172:175]
    ds_read_b64_tr_b16 v[210:211], v178 offset:4608
    s_waitcnt vmcnt(0) lgkmcnt(6)
    v_mfma_f32_16x16x32_bf16 v[160:163], v[216:219], v[88:91], v[160:163]
    ds_read_b64_tr_b16 v[212:213], v179 offset:4096
    v_mfma_f32_16x16x32_bf16 v[164:167], v[216:219], v[92:95], v[164:167]
    ds_read_b64_tr_b16 v[214:215], v179 offset:4608
    v_mfma_f32_16x16x32_bf16 v[168:171], v[220:223], v[88:91], v[168:171]
    v_mfma_f32_16x16x32_bf16 v[172:175], v[220:223], v[92:95], v[172:175]
    s_waitcnt lgkmcnt(4)
    v_mfma_f32_16x16x32_bf16 v[128:131], v[224:227], v[80:83], v[128:131]
    v_mfma_f32_16x16x32_bf16 v[132:135], v[224:227], v[84:87], v[132:135]
    v_mfma_f32_16x16x32_bf16 v[136:139], v[228:231], v[80:83], v[136:139]
    v_mfma_f32_16x16x32_bf16 v[140:143], v[228:231], v[84:87], v[140:143]
    s_nop 1
    ds_write_b128 v250, v[160:163] offset:0
    s_nop 0
    ds_write_b128 v250, v[164:167] offset:1024
    s_waitcnt lgkmcnt(2)
    v_mfma_f32_16x16x32_bf16 v[128:131], v[208:211], v[88:91], v[128:131]
    v_mfma_f32_16x16x32_bf16 v[132:135], v[208:211], v[92:95], v[132:135]
    ds_write_b128 v250, v[168:171] offset:2048
    ds_write_b128 v250, v[172:175] offset:3072
    v_mfma_f32_16x16x32_bf16 v[136:139], v[212:215], v[88:91], v[136:139]
    v_mfma_f32_16x16x32_bf16 v[140:143], v[212:215], v[92:95], v[140:143]
    s_waitcnt lgkmcnt(0)
    s_barrier
    ds_read_b128 v[144:147], v251 offset:0
    ds_read_b128 v[148:151], v251 offset:1024
    ds_read_b128 v[152:155], v251 offset:2048
    ds_read_b128 v[156:159], v251 offset:3072
    s_waitcnt lgkmcnt(3)
    v_add_f32 v144, v144, v128
    v_add_f32 v145, v145, v129
    v_add_f32 v146, v146, v130
    v_add_f32 v147, v147, v131
    s_waitcnt lgkmcnt(2)
    v_add_f32 v148, v148, v132
    v_add_f32 v149, v149, v133
    v_add_f32 v150, v150, v134
    v_add_f32 v151, v151, v135
    v_cvt_pk_bf16_f32 v232, v144, v145
    v_cvt_pk_bf16_f32 v233, v146, v147
    v_cvt_pk_bf16_f32 v234, v148, v149
    v_cvt_pk_bf16_f32 v235, v150, v151
    s_nop 0
    v_permlane16_swap_b32 v232, v234
    v_permlane16_swap_b32 v233, v235
    s_waitcnt lgkmcnt(1)
    v_add_f32 v152, v152, v136
    v_add_f32 v153, v153, v137
    v_add_f32 v154, v154, v138
    v_add_f32 v155, v155, v139
    s_waitcnt lgkmcnt(0)
    v_add_f32 v156, v156, v140
    v_add_f32 v157, v157, v141
    v_add_f32 v158, v158, v142
    v_add_f32 v159, v159, v143
    v_cvt_pk_bf16_f32 v236, v152, v153
    v_cvt_pk_bf16_f32 v237, v154, v155
    v_cvt_pk_bf16_f32 v238, v156, v157
    v_cvt_pk_bf16_f32 v239, v158, v159
    s_nop 0
    v_permlane16_swap_b32 v236, v238
    v_permlane16_swap_b32 v237, v239
    s_add_u32 s94, s95, 16384
    v_permlane16_swap_b32 v232, v236
    v_permlane16_swap_b32 v233, v237
    v_permlane16_swap_b32 v234, v238
    v_permlane16_swap_b32 v235, v239
    buffer_store_dwordx4 v[232:235], v249, s[44:47], s95 offen sc1
    buffer_store_dwordx4 v[236:239], v249, s[44:47], s94 offen sc1
    s_endpgm
.p2align 6
L_B:
    s_lshl_b32 s33, s21, 12
    v_lshlrev_b32 v245, 4, v235
    s_lshr_b32 s23, s21, 1
    s_and_b32 s22, s21, 1
    s_add_u32 s34, s34, s14
    s_sub_u32 s32, s34, 7
    s_min_u32 s34, s34, s32
    s_add_u32 s56, s30, 8388608
    s_addc_u32 s57, s31, 0
    s_mov_b32 s58, 114816
    s_mov_b32 s59, 0x20000
    v_lshlrev_b32 v180, 20, v235
    s_mov_b32 s74, s28
    s_mov_b32 s75, s29
    s_bfe_u32 s32, s15, 0x10002
    s_lshl1_add_u32 s0, s84, s32
    s_add_u32 s0, s0, 6
    s_xor_b32 s1, s0, 1
    s_lshl2_add_u32 s32, s21, 0
    s_lshr_b32 s32, s36, s32
    s_and_b32 s32, s32, 7
    s_lshl_b32 s32, s32, 7
    s_add_u32 s93, s32, s39
    s_lshl2_add_u32 s32, s21, 16
    s_lshr_b32 s32, s36, s32
    s_and_b32 s32, s32, 7
    s_lshl_b32 s32, s32, 7
    s_add_u32 s94, s32, s39
    s_lshl_b32 s32, s23, 2
    s_lshr_b32 s87, s36, s32
    v_mov_b32 v200, v192
    v_mov_b32 v201, v193
    v_mov_b32 v202, v194
    v_mov_b32 v203, v195
    s_mov_b32 s44, s40
    s_mov_b32 s45, s41
    s_mov_b32 s46, 1835008
    s_mov_b32 s47, 0x20000
    s_mov_b32 s38, s37
    s_mov_b32 s40, s4
    s_mov_b32 s41, s5
    s_mov_b32 s42, 0x200000
    v_lshrrev_b32 v232, 3, v235
    v_lshrrev_b32 v233, 4, v235
    v_xor_b32 v234, v233, v235
    v_and_b32 v234, 7, v234
    v_lshlrev_b32 v232, 10, v232
    v_lshl_add_u32 v192, v234, 4, v232
    v_xor_b32 v193, 64, v192
    v_add_u32 v193, 7168, v193
    v_add_u32 v194, 14336, v192
    v_add_u32 v195, 14336, v193
    v_and_b32 v232, 15, v235
    v_bfe_u32 v233, v235, 1, 3
    v_lshrrev_b32 v234, 4, v235
    v_xor_b32 v233, v233, v234
    v_lshlrev_b32 v232, 7, v232
    v_add_u32 v232, 0x20000, v232
    v_lshl_add_u32 v240, v233, 4, v232
    v_xor_b32 v241, 64, v240
    v_lshlrev_b32 v232, 3, v234
    v_bfe_u32 v233, v235, 2, 2
    v_add_u32 v232, v232, v233
    v_lshlrev_b32 v232, 7, v232
    v_bfe_u32 v233, v235, 4, 1
    v_bfe_u32 v234, v235, 3, 1
    v_lshl_add_u32 v233, v234, 1, v233
    v_xor_b32 v233, s21, v233
    v_lshl_add_u32 v232, v233, 5, v232
    v_and_b32 v233, 3, v235
    v_lshl_add_u32 v232, v233, 3, v232
    v_add_u32 v244, 0x10000, v232
    s_add_u32 m0, s33, 81920
    s_bfe_u32 s32, s36, 0x30004
    s_mul_i32 s32, s32, 229376
    s_add_u32 s32, s32, s38
    buffer_load_dwordx4 v200, s[44:47], s32 offen offset:0 lds
    buffer_load_dwordx4 v201, s[44:47], s32 offen offset:1024 lds
    buffer_load_dwordx4 v202, s[44:47], s32 offen offset:2048 lds
    buffer_load_dwordx4 v203, s[44:47], s32 offen offset:3072 lds
    s_mov_b32 s32, 0xc0135761
    s_mov_b32 s12, 0xbdd2d3e8
    v_mov_b32 v246, s32
    s_lshl2_add_u32 s13, s17, s21
    s_mul_i32 s32, s16, 896
    s_add_u32 s13, s13, s32
    s_mul_i32 s92, s16, 14336
    s_lshl_b32 s32, s17, 7
    s_add_u32 s92, s92, s32
    s_lshl2_add_u32 s92, s21, s92
    v_lshlrev_b32 v233, 2, v235
    v_lshrrev_b32 v232, 3, v235
    v_lshl_add_u32 v181, v232, 20, v233
    v_lshrrev_b32 v232, 2, v235
    v_lshl_add_u32 v180, v232, 20, v233
    s_lshl_b32 s32, s21, 24
    s_add_u32 s92, s92, s32
    s_mov_b32 s48, s10
    s_mov_b32 s49, s11
    s_mov_b32 s50, 1835008
    s_mov_b32 s51, 0x20000
    v_bfe_u32 v234, v235, 4, 1
    v_lshlrev_b32 v234, 2, v234
    v_xor_b32 v234, v234, v235
    v_and_b32 v234, 7, v234
    v_lshrrev_b32 v232, 3, v235
    v_lshlrev_b32 v232, 10, v232
    v_lshl_add_u32 v176, v234, 4, v232
    v_xor_b32 v177, 32, v176
    v_add_u32 v177, 7168, v177
    v_add_u32 v178, 14336, v176
    v_add_u32 v179, 14336, v177
    v_and_b32 v232, 15, v235
    s_lshl_b32 s32, s22, 1
    s_xor_b32 s32, s32, 2
    v_subrev_u32 v233, 10, v232
    v_xor_b32 v233, s32, v233
    v_add_u32 v233, 10, v233
    v_cmp_le_u32 vcc, 26, v235
    s_nop 1
    v_cndmask_b32 v232, v232, v233, vcc
    v_lshl_add_u32 v232, v232, 1, s23
    v_mul_u32_u24 v233, 37, v232
    v_lshrrev_b32 v233, 8, v233
    v_mul_u32_u24 v234, 7, v233
    v_sub_u32 v234, v232, v234
    v_add_u32 v234, s34, v234
    v_subrev_u32 v236, 7, v234
    v_min_u32 v236, v234, v236
    v_mul_u32_u24 v237, 86, v234
    v_lshrrev_b32 v237, 8, v237
    v_mul_u32_u24 v237, 3, v237
    v_sub_u32 v237, v234, v237
    v_lshl_add_u32 v237, v237, 1, 1
    v_cmp_le_u32 vcc, 21, v232
    v_and_b32 v234, 3, v234
    v_lshlrev_b32 v234, 1, v234
    v_cndmask_b32 v236, v236, v237, vcc
    v_cmp_le_u32 vcc, 24, v232
    v_sub_u32 v233, s35, v233
    v_and_b32 v233, 3, v233
    v_cndmask_b32 v236, v236, v234, vcc
    v_mad_u32_u24 v232, v233, 7, v236
    s_lshl_b32 s95, s19, 7
    s_lshl_b32 s32, s22, 15
    s_add_u32 s32, s32, s95
    v_lshl_add_u32 v233, v232, 16, s32
    s_mul_i32 s32, s18, 3584
    s_lshl4_add_u32 s32, s22, s32
    v_lshl_add_u32 v183, v232, 7, s32
    v_readlane_b32 s60, v233, 0
    v_readlane_b32 s61, v233, 1
    v_readlane_b32 s62, v233, 2
    v_readlane_b32 s63, v233, 3
    v_readlane_b32 s64, v233, 4
    v_readlane_b32 s65, v233, 5
    v_readlane_b32 s66, v233, 6
    v_readlane_b32 s67, v233, 7
    v_readlane_b32 s68, v233, 8
    v_readlane_b32 s69, v233, 9
    v_readlane_b32 s70, v233, 10
    v_readlane_b32 s71, v233, 11
    v_readlane_b32 s72, v233, 12
    v_readlane_b32 s73, v233, 13
    s_mov_b32 s52, s30
    s_mov_b32 s53, s31
    s_mov_b32 s54, 7340032
    s_mov_b32 s55, 0x20000
    s_branch L_bp0
.p2align 12
L_bp0:
    s_setprio 0
    s_waitcnt vmcnt(4)
    s_barrier
    s_add_u32 m0, s33, 98304
    s_bfe_u32 s32, s36, 0x30008
    s_mul_i32 s32, s32, 229376
    s_add_u32 s32, s32, s38
    buffer_load_dwordx4 v200, s[44:47], s32 offen offset:0 lds
    buffer_load_dwordx4 v201, s[44:47], s32 offen offset:1024 lds
    buffer_load_dwordx4 v202, s[44:47], s32 offen offset:2048 lds
    buffer_load_dwordx4 v203, s[44:47], s32 offen offset:3072 lds
    s_add_u32 m0, s33, 114688
    s_bfe_u32 s32, s36, 0x3000c
    s_mul_i32 s32, s32, 229376
    s_add_u32 s32, s32, s38
    buffer_load_dwordx4 v200, s[44:47], s32 offen offset:0 lds
    buffer_load_dwordx4 v201, s[44:47], s32 offen offset:1024 lds
    buffer_load_dwordx4 v202, s[44:47], s32 offen offset:2048 lds
    buffer_load_dwordx4 v203, s[44:47], s32 offen offset:3072 lds
    s_cmp_eq_u32 s21, 0
    s_cbranch_scc0 L_ntbr00
    s_call_b64 s[98:99], L_stub0
L_ntbr00:
    s_waitcnt vmcnt(8)
    s_barrier
    s_add_u32 m0, s33, 65536
    s_bfe_u32 s32, s36, 0x30010
    s_mul_i32 s32, s32, 229376
    s_add_u32 s32, s32, s38
    buffer_load_dwordx4 v200, s[44:47], s32 offen offset:0 lds
    buffer_load_dwordx4 v201, s[44:47], s32 offen offset:1024 lds
    buffer_load_dwordx4 v202, s[44:47], s32 offen offset:2048 lds
    buffer_load_dwordx4 v203, s[44:47], s32 offen offset:3072 lds
    s_add_u32 m0, s33, 32768
    s_bfe_u32 s32, s87, 0x30010
    s_lshl_b32 s32, s32, 7
    s_add_u32 s32, s32, s3
    buffer_load_dwordx4 v192, s[40:43], s32 offen offset:0 lds
    buffer_load_dwordx4 v193, s[40:43], s32 offen offset:1024 lds
    buffer_load_dwordx4 v194, s[40:43], s32 offen offset:2048 lds
    buffer_load_dwordx4 v195, s[40:43], s32 offen offset:3072 lds
    s_waitcnt vmcnt(12)
    s_barrier
    s_add_u32 m0, s33, 81920
    s_bfe_u32 s32, s36, 0x30014
    s_mul_i32 s32, s32, 229376
    s_add_u32 s32, s32, s38
    buffer_load_dwordx4 v200, s[44:47], s32 offen offset:0 lds
    buffer_load_dwordx4 v201, s[44:47], s32 offen offset:1024 lds
    buffer_load_dwordx4 v202, s[44:47], s32 offen offset:2048 lds
    buffer_load_dwordx4 v203, s[44:47], s32 offen offset:3072 lds
    s_waitcnt vmcnt(12)
    s_barrier
    s_add_u32 m0, s33, 98304
    s_bfe_u32 s32, s36, 0x30018
    s_mul_i32 s32, s32, 229376
    s_add_u32 s32, s32, s38
    buffer_load_dwordx4 v200, s[44:47], s32 offen offset:0 lds
    buffer_load_dwordx4 v201, s[44:47], s32 offen offset:1024 lds
    buffer_load_dwordx4 v202, s[44:47], s32 offen offset:2048 lds
    buffer_load_dwordx4 v203, s[44:47], s32 offen offset:3072 lds
    s_add_u32 m0, s33, 0
    s_bfe_u32 s32, s87, 0x30018
    s_lshl_b32 s32, s32, 7
    s_add_u32 s32, s32, s3
    buffer_load_dwordx4 v192, s[40:43], s32 offen offset:0 lds
    buffer_load_dwordx4 v193, s[40:43], s32 offen offset:1024 lds
    buffer_load_dwordx4 v194, s[40:43], s32 offen offset:2048 lds
    buffer_load_dwordx4 v195, s[40:43], s32 offen offset:3072 lds
    s_waitcnt vmcnt(12)
    s_barrier
    s_add_u32 m0, s33, 114688
    s_bfe_u32 s32, s36, 0x3001c
    s_mul_i32 s32, s32, 229376
    s_add_u32 s32, s32, s38
    buffer_load_dwordx4 v200, s[44:47], s32 offen offset:0 lds
    buffer_load_dwordx4 v201, s[44:47], s32 offen offset:1024 lds
    buffer_load_dwordx4 v202, s[44:47], s32 offen offset:2048 lds
    buffer_load_dwordx4 v203, s[44:47], s32 offen offset:3072 lds
    s_waitcnt vmcnt(12)
    s_barrier
    s_add_u32 m0, s33, 16384
    s_lshl1_add_u32 s32, s84, 2
    s_and_b32 s32, s32, 7
    s_lshl_b32 s32, s32, 15
    s_add_u32 s32, s32, s93
    buffer_load_dwordx4 v192, s[40:43], s32 offen offset:0 lds
    buffer_load_dwordx4 v193, s[40:43], s32 offen offset:1024 lds
    buffer_load_dwordx4 v194, s[40:43], s32 offen offset:2048 lds
    buffer_load_dwordx4 v195, s[40:43], s32 offen offset:3072 lds
    s_waitcnt vmcnt(8)
    s_barrier
    s_add_u32 m0, s33, 32768
    s_lshl1_add_u32 s32, s84, 2
    s_and_b32 s32, s32, 7
    s_lshl_b32 s32, s32, 15
    s_add_u32 s32, s32, s94
    buffer_load_dwordx4 v192, s[40:43], s32 offen offset:0 lds
    buffer_load_dwordx4 v193, s[40:43], s32 offen offset:1024 lds
    buffer_load_dwordx4 v194, s[40:43], s32 offen offset:2048 lds
    buffer_load_dwordx4 v195, s[40:43], s32 offen offset:3072 lds
    s_add_u32 m0, s33, 49152
    s_nop 0
    buffer_load_dwordx4 v176, s[48:51], s60 offen offset:0 lds
    buffer_load_dwordx4 v177, s[48:51], s60 offen offset:1024 lds
    buffer_load_dwordx4 v178, s[48:51], s60 offen offset:2048 lds
    buffer_load_dwordx4 v179, s[48:51], s60 offen offset:3072 lds
    s_load_dwordx2 s[14:15], s[74:75], 0
    s_load_dword s4, s[56:57], 114752
    s_waitcnt vmcnt(12)
    s_barrier
    buffer_load_dwordx4 v[0:3], v176, s[48:51], s67 offen offset:0
    buffer_load_dwordx4 v[4:7], v177, s[48:51], s67 offen offset:1024
    buffer_load_dwordx4 v[8:11], v178, s[48:51], s67 offen offset:2048
    buffer_load_dwordx4 v[12:15], v179, s[48:51], s67 offen offset:3072
    s_waitcnt vmcnt(12)
    s_barrier
    s_add_u32 m0, s33, 0
    s_lshl1_add_u32 s32, s84, 3
    s_and_b32 s32, s32, 7
    s_lshl_b32 s32, s32, 15
    s_add_u32 s32, s32, s93
    buffer_load_dwordx4 v192, s[40:43], s32 offen offset:0 lds
    buffer_load_dwordx4 v193, s[40:43], s32 offen offset:1024 lds
    buffer_load_dwordx4 v194, s[40:43], s32 offen offset:2048 lds
    buffer_load_dwordx4 v195, s[40:43], s32 offen offset:3072 lds
    s_add_u32 m0, s33, 131072
    s_nop 0
    buffer_load_dwordx4 v176, s[48:51], s64 offen offset:0 lds
    buffer_load_dwordx4 v177, s[48:51], s64 offen offset:1024 lds
    buffer_load_dwordx4 v178, s[48:51], s64 offen offset:2048 lds
    buffer_load_dwordx4 v179, s[48:51], s64 offen offset:3072 lds
    s_cmp_eq_u32 s21, 1
    s_cbranch_scc0 L_ntbr01
    s_call_b64 s[98:99], L_stub1
L_ntbr01:
    s_waitcnt vmcnt(16)
    s_barrier
    s_add_u32 m0, s33, 16384
    s_lshl1_add_u32 s32, s84, 3
    s_and_b32 s32, s32, 7
    s_lshl_b32 s32, s32, 15
    s_add_u32 s32, s32, s94
    buffer_load_dwordx4 v192, s[40:43], s32 offen offset:0 lds
    buffer_load_dwordx4 v193, s[40:43], s32 offen offset:1024 lds
    buffer_load_dwordx4 v194, s[40:43], s32 offen offset:2048 lds
    buffer_load_dwordx4 v195, s[40:43], s32 offen offset:3072 lds
    s_add_u32 m0, s33, 65536
    s_nop 0
    buffer_load_dwordx4 v176, s[48:51], s61 offen offset:0 lds
    buffer_load_dwordx4 v177, s[48:51], s61 offen offset:1024 lds
    buffer_load_dwordx4 v178, s[48:51], s61 offen offset:2048 lds
    buffer_load_dwordx4 v179, s[48:51], s61 offen offset:3072 lds
    s_waitcnt vmcnt(12)
    s_barrier
    s_add_u32 m0, s33, 32768
    s_lshl1_add_u32 s32, s84, 4
    s_and_b32 s32, s32, 7
    s_lshl_b32 s32, s32, 15
    s_add_u32 s32, s32, s93
    buffer_load_dwordx4 v192, s[40:43], s32 offen offset:0 lds
    buffer_load_dwordx4 v193, s[40:43], s32 offen offset:1024 lds
    buffer_load_dwordx4 v194, s[40:43], s32 offen offset:2048 lds
    buffer_load_dwordx4 v195, s[40:43], s32 offen offset:3072 lds
    buffer_load_dwordx4 v[16:19], v176, s[48:51], s68 offen offset:0
    buffer_load_dwordx4 v[20:23], v177, s[48:51], s68 offen offset:1024
    buffer_load_dwordx4 v[24:27], v178, s[48:51], s68 offen offset:2048
    buffer_load_dwordx4 v[28:31], v179, s[48:51], s68 offen offset:3072
    s_waitcnt vmcnt(12)
    s_barrier
    s_add_u32 m0, s33, 0
    s_lshl1_add_u32 s32, s84, 4
    s_and_b32 s32, s32, 7
    s_lshl_b32 s32, s32, 15
    s_add_u32 s32, s32, s94
    buffer_load_dwordx4 v192, s[40:43], s32 offen offset:0 lds
    buffer_load_dwordx4 v193, s[40:43], s32 offen offset:1024 lds
    buffer_load_dwordx4 v194, s[40:43], s32 offen offset:2048 lds
    buffer_load_dwordx4 v195, s[40:43], s32 offen offset:3072 lds
    s_add_u32 m0, s33, 114688
    s_nop 0
    buffer_load_dwordx4 v176, s[48:51], s65 offen offset:0 lds
    buffer_load_dwordx4 v177, s[48:51], s65 offen offset:1024 lds
    buffer_load_dwordx4 v178, s[48:51], s65 offen offset:2048 lds
    buffer_load_dwordx4 v179, s[48:51], s65 offen offset:3072 lds
    s_mov_b32 s97, 0
    s_waitcnt lgkmcnt(0)
L_tagbr0:
    s_cmp_lg_u32 s15, 0
    s_cbranch_scc1 L_tagokbr0
    s_add_u32 s97, s97, 1
    s_cmp_ge_u32 s97, 0x100000
    s_cbranch_scc1 L_tagokbr0
    s_sleep 2
    v_mov_b32 v198, 0
    global_load_dwordx2 v[196:197], v198, s[74:75] sc1
    s_waitcnt vmcnt(0)
    v_readfirstlane_b32 s14, v196
    v_readfirstlane_b32 s15, v197
    s_nop 1
    s_branch L_tagbr0
L_tagokbr0:
    v_mov_b32 v182, s14
    s_mov_b32 s15, s14
    s_waitcnt vmcnt(12)
    s_barrier
    s_add_u32 m0, s33, 16384
    s_lshl1_add_u32 s32, s84, 5
    s_and_b32 s32, s32, 7
    s_lshl_b32 s32, s32, 15
    s_add_u32 s32, s32, s93
    buffer_load_dwordx4 v192, s[40:43], s32 offen offset:0 lds
    buffer_load_dwordx4 v193, s[40:43], s32 offen offset:1024 lds
    buffer_load_dwordx4 v194, s[40:43], s32 offen offset:2048 lds
    buffer_load_dwordx4 v195, s[40:43], s32 offen offset:3072 lds
    s_add_u32 m0, s33, 81920
    s_nop 0
    buffer_load_dwordx4 v176, s[48:51], s62 offen offset:0 lds
    buffer_load_dwordx4 v177, s[48:51], s62 offen offset:1024 lds
    buffer_load_dwordx4 v178, s[48:51], s62 offen offset:2048 lds
    buffer_load_dwordx4 v179, s[48:51], s62 offen offset:3072 lds
    s_waitcnt vmcnt(12)
    s_barrier
    s_add_u32 s97, s84, 0
    s_and_b32 s97, s97, 3
    s_mul_i32 s97, s97, 3584
    s_add_u32 s97, s97, s92
    buffer_store_dword v182, v181, s[56:59], s97 offen sc1
    s_add_u32 m0, s33, 32768
    s_lshl1_add_u32 s32, s84, 5
    s_and_b32 s32, s32, 7
    s_lshl_b32 s32, s32, 15
    s_add_u32 s32, s32, s94
    buffer_load_dwordx4 v192, s[40:43], s32 offen offset:0 lds
    buffer_load_dwordx4 v193, s[40:43], s32 offen offset:1024 lds
    buffer_load_dwordx4 v194, s[40:43], s32 offen offset:2048 lds
    buffer_load_dwordx4 v195, s[40:43], s32 offen offset:3072 lds
    buffer_load_dwordx4 v[32:35], v176, s[48:51], s69 offen offset:0
    buffer_load_dwordx4 v[36:39], v177, s[48:51], s69 offen offset:1024
    buffer_load_dwordx4 v[40:43], v178, s[48:51], s69 offen offset:2048
    buffer_load_dwordx4 v[44:47], v179, s[48:51], s69 offen offset:3072
    s_waitcnt vmcnt(13)
    s_barrier
    s_add_u32 m0, s33, 0
    s_and_b32 s32, s0, 7
    s_lshl_b32 s32, s32, 15
    s_add_u32 s32, s32, s93
    buffer_load_dwordx4 v192, s[40:43], s32 offen offset:0 lds
    buffer_load_dwordx4 v193, s[40:43], s32 offen offset:1024 lds
    buffer_load_dwordx4 v194, s[40:43], s32 offen offset:2048 lds
    buffer_load_dwordx4 v195, s[40:43], s32 offen offset:3072 lds
    s_add_u32 m0, s33, 147456
    s_nop 0
    buffer_load_dwordx4 v176, s[48:51], s66 offen offset:0 lds
    buffer_load_dwordx4 v177, s[48:51], s66 offen offset:1024 lds
    buffer_load_dwordx4 v178, s[48:51], s66 offen offset:2048 lds
    buffer_load_dwordx4 v179, s[48:51], s66 offen offset:3072 lds
    s_cmp_eq_u32 s21, 2
    s_cbranch_scc0 L_ntbr02
    s_call_b64 s[98:99], L_stub2
L_ntbr02:
    s_waitcnt vmcnt(12)
    s_barrier
    s_add_u32 m0, s33, 16384
    s_and_b32 s32, s0, 7
    s_lshl_b32 s32, s32, 15
    s_add_u32 s32, s32, s94
    buffer_load_dwordx4 v192, s[40:43], s32 offen offset:0 lds
    buffer_load_dwordx4 v193, s[40:43], s32 offen offset:1024 lds
    buffer_load_dwordx4 v194, s[40:43], s32 offen offset:2048 lds
    buffer_load_dwordx4 v195, s[40:43], s32 offen offset:3072 lds
    s_add_u32 m0, s33, 98304
    s_nop 0
    buffer_load_dwordx4 v176, s[48:51], s63 offen offset:0 lds
    buffer_load_dwordx4 v177, s[48:51], s63 offen offset:1024 lds
    buffer_load_dwordx4 v178, s[48:51], s63 offen offset:2048 lds
    buffer_load_dwordx4 v179, s[48:51], s63 offen offset:3072 lds
    s_waitcnt vmcnt(12)
    s_barrier
    s_add_u32 s97, s84, 1
    s_and_b32 s97, s97, 3
    s_mul_i32 s97, s97, 3584
    s_add_u32 s97, s97, s92
    buffer_store_dword v182, v181, s[56:59], s97 offen sc1
    s_add_u32 s88, s22, 16
    s_min_u32 s88, s88, 18
    s_add_u32 s89, s22, 18
    s_min_u32 s89, s89, 18
    v_readlane_b32 s88, v183, s88
    v_readlane_b32 s89, v183, s89
    s_nop 3
    s_load_dwordx4 s[4:7], s[56:57], s88 glc
    s_load_dwordx4 s[8:11], s[56:57], s89 glc
    s_add_u32 m0, s33, 32768
    s_and_b32 s32, s1, 7
    s_lshl_b32 s32, s32, 15
    s_add_u32 s32, s32, s93
    buffer_load_dwordx4 v192, s[40:43], s32 offen offset:0 lds
    buffer_load_dwordx4 v193, s[40:43], s32 offen offset:1024 lds
    buffer_load_dwordx4 v194, s[40:43], s32 offen offset:2048 lds
    buffer_load_dwordx4 v195, s[40:43], s32 offen offset:3072 lds
    buffer_load_dwordx4 v[48:51], v176, s[48:51], s70 offen offset:0
    buffer_load_dwordx4 v[52:55], v177, s[48:51], s70 offen offset:1024
    buffer_load_dwordx4 v[56:59], v178, s[48:51], s70 offen offset:2048
    buffer_load_dwordx4 v[60:63], v179, s[48:51], s70 offen offset:3072
    s_waitcnt vmcnt(13)
    s_barrier
    s_add_u32 m0, s33, 0
    s_and_b32 s32, s1, 7
    s_lshl_b32 s32, s32, 15
    s_add_u32 s32, s32, s94
    buffer_load_dwordx4 v192, s[40:43], s32 offen offset:0 lds
    buffer_load_dwordx4 v193, s[40:43], s32 offen offset:1024 lds
    buffer_load_dwordx4 v194, s[40:43], s32 offen offset:2048 lds
    buffer_load_dwordx4 v195, s[40:43], s32 offen offset:3072 lds
    buffer_load_dwordx4 v[64:67], v176, s[48:51], s71 offen offset:0
    buffer_load_dwordx4 v[68:71], v177, s[48:51], s71 offen offset:1024
    buffer_load_dwordx4 v[72:75], v178, s[48:51], s71 offen offset:2048
    buffer_load_dwordx4 v[76:79], v179, s[48:51], s71 offen offset:3072
    s_mov_b32 s96, 0
L_pollbr00:
    s_waitcnt lgkmcnt(0)
    s_xor_b64 s[4:5], s[4:5], s[14:15]
    s_xor_b64 s[6:7], s[6:7], s[14:15]
    s_xor_b64 s[8:9], s[8:9], s[14:15]
    s_xor_b64 s[10:11], s[10:11], s[14:15]
    s_or_b64 s[4:5], s[4:5], s[6:7]
    s_or_b64 s[4:5], s[4:5], s[8:9]
    s_or_b64 s[4:5], s[4:5], s[10:11]
    s_cbranch_scc0 L_okbr00
    s_add_u32 s96, s96, 1
    s_cmp_ge_u32 s96, 0x100000
    s_cbranch_scc1 L_okbr00
    s_and_b32 s4, s96, 63
    s_cbranch_scc1 L_spbr00
    s_mov_b64 exec, 0x70000
    buffer_load_dwordx4 v[196:199], v183, s[56:59], 0 offen sc1
    s_mov_b64 exec, -1
    s_waitcnt vmcnt(0)
    v_cmp_eq_u64 vcc, s[14:15], v[196:197]
    v_cmp_eq_u64_e64 s[4:5], s[14:15], v[198:199]
    s_nop 1
    s_and_b32 s4, s4, vcc_lo
    s_andn2_b32 s4, 0x70000, s4
    s_cbranch_scc0 L_okbr00
L_spbr00:
    s_load_dwordx4 s[4:7], s[56:57], s88 glc
    s_load_dwordx4 s[8:11], s[56:57], s89 glc
    s_branch L_pollbr00
L_okbr00:
    s_waitcnt vmcnt(12)
    s_barrier
    buffer_load_dwordx4 v[80:83], v176, s[48:51], s72 offen offset:0
    buffer_load_dwordx4 v[84:87], v177, s[48:51], s72 offen offset:1024
    buffer_load_dwordx4 v[88:91], v178, s[48:51], s72 offen offset:2048
    buffer_load_dwordx4 v[92:95], v179, s[48:51], s72 offen offset:3072
    s_add_u32 s88, s22, 19
    s_min_u32 s88, s88, 22
    s_add_u32 s89, s22, 21
    s_min_u32 s89, s89, 22
    v_readlane_b32 s88, v183, s88
    v_readlane_b32 s89, v183, s89
    s_nop 3
    s_load_dwordx4 s[4:7], s[56:57], s88 glc
    s_load_dwordx4 s[8:11], s[56:57], s89 glc
    s_waitcnt vmcnt(8)
    s_barrier
    s_add_u32 s97, s84, 2
    s_and_b32 s97, s97, 3
    s_mul_i32 s97, s97, 3584
    s_add_u32 s97, s97, s92
    buffer_store_dword v182, v181, s[56:59], s97 offen sc1
    buffer_load_dwordx4 v[96:99], v176, s[48:51], s73 offen offset:0
    buffer_load_dwordx4 v[100:103], v177, s[48:51], s73 offen offset:1024
    buffer_load_dwordx4 v[104:107], v178, s[48:51], s73 offen offset:2048
    buffer_load_dwordx4 v[108:111], v179, s[48:51], s73 offen offset:3072
    s_mov_b32 s96, 0
L_pollbr01:
    s_waitcnt lgkmcnt(0)
    s_xor_b64 s[4:5], s[4:5], s[14:15]
    s_xor_b64 s[6:7], s[6:7], s[14:15]
    s_xor_b64 s[8:9], s[8:9], s[14:15]
    s_xor_b64 s[10:11], s[10:11], s[14:15]
    s_or_b64 s[4:5], s[4:5], s[6:7]
    s_or_b64 s[4:5], s[4:5], s[8:9]
    s_or_b64 s[4:5], s[4:5], s[10:11]
    s_cbranch_scc0 L_okbr01
    s_add_u32 s96, s96, 1
    s_cmp_ge_u32 s96, 0x100000
    s_cbranch_scc1 L_okbr01
    s_and_b32 s4, s96, 63
    s_cbranch_scc1 L_spbr01
    s_mov_b64 exec, 0x780000
    buffer_load_dwordx4 v[196:199], v183, s[56:59], 0 offen sc1
    s_mov_b64 exec, -1
    s_waitcnt vmcnt(0)
    v_cmp_eq_u64 vcc, s[14:15], v[196:197]
    v_cmp_eq_u64_e64 s[4:5], s[14:15], v[198:199]
    s_nop 1
    s_and_b32 s4, s4, vcc_lo
    s_andn2_b32 s4, 0x780000, s4
    s_cbranch_scc0 L_okbr01
L_spbr01:
    s_load_dwordx4 s[4:7], s[56:57], s88 glc
    s_load_dwordx4 s[8:11], s[56:57], s89 glc
    s_branch L_pollbr01
L_okbr01:
    s_cmp_eq_u32 s21, 3
    s_cbranch_scc0 L_ntbr03
    s_call_b64 s[98:99], L_stub3
L_ntbr03:
    s_barrier
    s_add_u32 s32, s33, 16384
    v_add_u32 v243, s32, v245
    ds_write_b128 v243, v[0:3] offset:0
    ds_write_b128 v243, v[4:7] offset:1024
    ds_write_b128 v243, v[8:11] offset:2048
    ds_write_b128 v243, v[12:15] offset:3072
    s_add_u32 s32, s33, 32768
    v_add_u32 v243, s32, v245
    ds_write_b128 v243, v[16:19] offset:0
    ds_write_b128 v243, v[20:23] offset:1024
    ds_write_b128 v243, v[24:27] offset:2048
    ds_write_b128 v243, v[28:31] offset:3072
    s_add_u32 s32, s33, 0
    v_add_u32 v243, s32, v245
    ds_write_b128 v243, v[32:35] offset:0
    ds_write_b128 v243, v[36:39] offset:1024
    ds_write_b128 v243, v[40:43] offset:2048
    ds_write_b128 v243, v[44:47] offset:3072
    s_add_u32 s88, s22, 23
    s_min_u32 s88, s88, 25
    s_add_u32 s89, s22, 25
    s_min_u32 s89, s89, 25
    v_readlane_b32 s88, v183, s88
    v_readlane_b32 s89, v183, s89
    s_waitcnt lgkmcnt(0)
    s_nop 3
    s_load_dwordx4 s[4:7], s[56:57], s88 glc
    s_load_dwordx4 s[8:11], s[56:57], s89 glc
    s_barrier
    s_add_u32 s97, s84, 3
    s_and_b32 s97, s97, 3
    s_mul_i32 s97, s97, 3584
    s_add_u32 s97, s97, s92
    s_and_b32 s13, s0, 1
    s_lshl4_add_u32 s97, s13, s97
    buffer_store_dword v182, v180, s[56:59], s97 offen sc1
    s_add_u32 s32, s33, 49152
    v_add_u32 v243, s32, v245
    ds_write_b128 v243, v[48:51] offset:0
    ds_write_b128 v243, v[52:55] offset:1024
    ds_write_b128 v243, v[56:59] offset:2048
    ds_write_b128 v243, v[60:63] offset:3072
    s_mov_b32 s96, 0
L_pollbr02:
    s_waitcnt lgkmcnt(0)
    s_waitcnt lgkmcnt(0)
    s_xor_b64 s[4:5], s[4:5], s[14:15]
    s_xor_b64 s[6:7], s[6:7], s[14:15]
    s_xor_b64 s[8:9], s[8:9], s[14:15]
    s_xor_b64 s[10:11], s[10:11], s[14:15]
    s_or_b64 s[4:5], s[4:5], s[6:7]
    s_or_b64 s[4:5], s[4:5], s[8:9]
    s_or_b64 s[4:5], s[4:5], s[10:11]
    s_cbranch_scc0 L_okbr02
    s_add_u32 s96, s96, 1
    s_cmp_ge_u32 s96, 0x100000
    s_cbranch_scc1 L_okbr02
    s_and_b32 s4, s96, 63
    s_cbranch_scc1 L_spbr02
    s_mov_b64 exec, 0x3800000
    buffer_load_dwordx4 v[196:199], v183, s[56:59], 0 offen sc1
    s_mov_b64 exec, -1
    s_waitcnt vmcnt(0)
    v_cmp_eq_u64 vcc, s[14:15], v[196:197]
    v_cmp_eq_u64_e64 s[4:5], s[14:15], v[198:199]
    s_nop 1
    s_and_b32 s4, s4, vcc_lo
    s_andn2_b32 s4, 0x3800000, s4
    s_cbranch_scc0 L_okbr02
L_spbr02:
    s_load_dwordx4 s[4:7], s[56:57], s88 glc
    s_load_dwordx4 s[8:11], s[56:57], s89 glc
    s_branch L_pollbr02
L_okbr02:
    s_barrier
    s_add_u32 s97, s84, 3
    s_and_b32 s97, s97, 3
    s_mul_i32 s97, s97, 3584
    s_add_u32 s97, s97, s92
    s_and_b32 s13, s1, 1
    s_lshl4_add_u32 s97, s13, s97
    buffer_store_dword v182, v180, s[56:59], s97 offen sc1
    s_add_u32 s32, s33, 65536
    v_add_u32 v243, s32, v245
    s_waitcnt vmcnt(14)
    ds_write_b128 v243, v[64:67] offset:0
    s_waitcnt vmcnt(13)
    ds_write_b128 v243, v[68:71] offset:1024
    s_waitcnt vmcnt(12)
    ds_write_b128 v243, v[72:75] offset:2048
    s_waitcnt vmcnt(11)
    ds_write_b128 v243, v[76:79] offset:3072
    s_add_u32 s32, s33, 81920
    v_add_u32 v243, s32, v245
    s_waitcnt vmcnt(10)
    ds_write_b128 v243, v[80:83] offset:0
    s_waitcnt vmcnt(9)
    ds_write_b128 v243, v[84:87] offset:1024
    s_waitcnt vmcnt(8)
    ds_write_b128 v243, v[88:91] offset:2048
    s_waitcnt vmcnt(7)
    ds_write_b128 v243, v[92:95] offset:3072
    v_readlane_b32 s88, v183, 26
    v_readlane_b32 s89, v183, 27
    s_waitcnt lgkmcnt(0)
    s_nop 3
    s_load_dwordx4 s[4:7], s[56:57], s88 glc
    s_load_dwordx4 s[8:11], s[56:57], s89 glc
    s_barrier
    s_add_u32 s32, s33, 98304
    v_add_u32 v243, s32, v245
    s_waitcnt vmcnt(5)
    ds_write_b128 v243, v[96:99] offset:0
    s_waitcnt vmcnt(4)
    ds_write_b128 v243, v[100:103] offset:1024
    s_waitcnt vmcnt(3)
    ds_write_b128 v243, v[104:107] offset:2048
    s_waitcnt vmcnt(2)
    ds_write_b128 v243, v[108:111] offset:3072
    s_mov_b32 s96, 0
L_pollbr03:
    s_waitcnt lgkmcnt(0)
    s_waitcnt lgkmcnt(0)
    s_xor_b64 s[4:5], s[4:5], s[14:15]
    s_xor_b64 s[6:7], s[6:7], s[14:15]
    s_xor_b64 s[8:9], s[8:9], s[14:15]
    s_xor_b64 s[10:11], s[10:11], s[14:15]
    s_or_b64 s[4:5], s[4:5], s[6:7]
    s_or_b64 s[4:5], s[4:5], s[8:9]
    s_or_b64 s[4:5], s[4:5], s[10:11]
    s_cbranch_scc0 L_okbr03
    s_add_u32 s96, s96, 1
    s_cmp_ge_u32 s96, 0x100000
    s_cbranch_scc1 L_okbr03
    s_and_b32 s4, s96, 63
    s_cbranch_scc1 L_spbr03
    s_mov_b64 exec, 0xc000000
    buffer_load_dwordx4 v[196:199], v183, s[56:59], 0 offen sc1
    s_mov_b64 exec, -1
    s_waitcnt vmcnt(0)
    v_cmp_eq_u64 vcc, s[14:15], v[196:197]
    v_cmp_eq_u64_e64 s[4:5], s[14:15], v[198:199]
    s_nop 1
    s_and_b32 s4, s4, vcc_lo
    s_andn2_b32 s4, 0xc000000, s4
    s_cbranch_scc0 L_okbr03
L_spbr03:
    s_load_dwordx4 s[4:7], s[56:57], s88 glc
    s_load_dwordx4 s[8:11], s[56:57], s89 glc
    s_branch L_pollbr03
L_okbr03:
    v_readlane_b32 s88, v183, 28
    v_readlane_b32 s89, v183, 29
    s_nop 3
    s_load_dwordx4 s[4:7], s[56:57], s88 glc
    s_load_dwordx4 s[8:11], s[56:57], s89 glc
    s_barrier
    s_mov_b32 s96, 0
L_pollbr04:
    s_waitcnt lgkmcnt(0)
    s_xor_b64 s[4:5], s[4:5], s[14:15]
    s_xor_b64 s[6:7], s[6:7], s[14:15]
    s_xor_b64 s[8:9], s[8:9], s[14:15]
    s_xor_b64 s[10:11], s[10:11], s[14:15]
    s_or_b64 s[4:5], s[4:5], s[6:7]
    s_or_b64 s[4:5], s[4:5], s[8:9]
    s_or_b64 s[4:5], s[4:5], s[10:11]
    s_cbranch_scc0 L_okbr04
    s_add_u32 s96, s96, 1
    s_cmp_ge_u32 s96, 0x100000
    s_cbranch_scc1 L_okbr04
    s_and_b32 s4, s96, 63
    s_cbranch_scc1 L_spbr04
    s_mov_b64 exec, 0x30000000
    buffer_load_dwordx4 v[196:199], v183, s[56:59], 0 offen sc1
    s_mov_b64 exec, -1
    s_waitcnt vmcnt(0)
    v_cmp_eq_u64 vcc, s[14:15], v[196:197]
    v_cmp_eq_u64_e64 s[4:5], s[14:15], v[198:199]
    s_nop 1
    s_and_b32 s4, s4, vcc_lo
    s_andn2_b32 s4, 0x30000000, s4
    s_cbranch_scc0 L_okbr04
L_spbr04:
    s_load_dwordx4 s[4:7], s[56:57], s88 glc
    s_load_dwordx4 s[8:11], s[56:57], s89 glc
    s_branch L_pollbr04
L_okbr04:
    s_barrier
    s_endpgm
.p2align 6
L_spare:
    s_cmp_lt_u32 s20, 4
    s_cbranch_scc0 L_Bs
    v_and_b32 v235, 63, v0
    s_waitcnt lgkmcnt(0)
    s_lshl_b32 s33, s21, 12
    v_lshlrev_b32 v245, 4, v235
    s_lshr_b32 s23, s21, 1
    s_and_b32 s22, s21, 1
    s_add_u32 s34, s34, s14
    s_sub_u32 s32, s34, 7
    s_min_u32 s34, s34, s32
    s_mov_b32 s48, s10
    s_mov_b32 s49, s11
    s_mov_b32 s50, 1835008
    s_mov_b32 s51, 0x20000
    v_and_b32 v232, 15, v235
    s_lshl_b32 s32, s22, 1
    s_xor_b32 s32, s32, 2
    v_subrev_u32 v233, 10, v232
    v_xor_b32 v233, s32, v233
    v_add_u32 v233, 10, v233
    v_cmp_le_u32 vcc, 26, v235
    s_nop 1
    v_cndmask_b32 v232, v232, v233, vcc
    v_lshl_add_u32 v232, v232, 1, s23
    v_mul_u32_u24 v233, 37, v232
    v_lshrrev_b32 v233, 8, v233
    v_mul_u32_u24 v234, 7, v233
    v_sub_u32 v234, v232, v234
    v_add_u32 v234, s34, v234
    v_subrev_u32 v236, 7, v234
    v_min_u32 v236, v234, v236
    v_mul_u32_u24 v237, 86, v234
    v_lshrrev_b32 v237, 8, v237
    v_mul_u32_u24 v237, 3, v237
    v_sub_u32 v237, v234, v237
    v_lshl_add_u32 v237, v237, 1, 1
    v_cmp_le_u32 vcc, 21, v232
    v_and_b32 v234, 3, v234
    v_lshlrev_b32 v234, 1, v234
    v_cndmask_b32 v236, v236, v237, vcc
    v_cmp_le_u32 vcc, 24, v232
    v_sub_u32 v233, s35, v233
    v_and_b32 v233, 3, v233
    v_cndmask_b32 v236, v236, v234, vcc
    v_mad_u32_u24 v232, v233, 7, v236
    s_lshl_b32 s95, s19, 7
    s_lshl1_add_u32 s32, s18, s22
    s_mul_i32 s32, s32, 114688
    v_lshl_add_u32 v233, v232, 12, s32
    v_lshrrev_b32 v232, 5, v235
    v_readlane_b32 s60, v233, 16
    v_readlane_b32 s61, v233, 17
    v_readlane_b32 s62, v233, 18
    v_readlane_b32 s63, v233, 19
    v_readlane_b32 s64, v233, 20
    v_readlane_b32 s65, v233, 21
    v_readlane_b32 s66, v233, 22
    v_readlane_b32 s67, v233, 23
    v_readlane_b32 s68, v233, 24
    v_readlane_b32 s69, v233, 25
    v_readlane_b32 s70, v233, 26
    v_readlane_b32 s71, v233, 27
    v_readlane_b32 s72, v233, 28
    v_readlane_b32 s73, v233, 29
    v_lshrrev_b32 v232, 4, v235
    v_lshlrev_b32 v232, 3, v232
    v_bfe_u32 v233, v235, 2, 2
    v_add_u32 v232, v232, v233
    v_lshlrev_b32 v232, 7, v232
    v_bfe_u32 v233, v235, 3, 1
    v_lshl_add_u32 v232, v233, 6, v232
    v_bfe_u32 v233, v235, 4, 1
    v_lshl_add_u32 v232, v233, 5, v232
    v_and_b32 v233, 3, v235
    v_lshl_add_u32 v232, v233, 3, v232
    s_lshl_b32 s32, s23, 13
    s_add_u32 s32, s32, 49152
    v_add_u32 v178, s32, v232
    s_lshl_b32 s32, s23, 6
    v_xor_b32 v178, s32, v178
    v_xor_b32 v179, 32, v178
    v_xor_b32 v176, 64, v178
    v_xor_b32 v177, 64, v179
    v_lshrrev_b32 v232, 4, v235
    v_lshlrev_b32 v232, 9, v232
    v_and_b32 v233, 0xf0, v245
    v_add_u32 v180, v232, v233
    s_cmp_eq_u32 s22, 1
    s_cselect_b32 s88, 3, 5
    s_cselect_b32 s89, 1, 1
    s_cselect_b32 s90, 1, -3
    s_cselect_b32 s91, 1, 1
    s_lshl_b32 s88, s88, 14
    s_lshl_b32 s89, s89, 14
    s_lshl_b32 s90, s90, 14
    s_lshl_b32 s91, s91, 14
    s_mov_b32 s44, s26
    s_mov_b32 s45, s27
    s_mov_b32 s46, 0x200000
    s_mov_b32 s47, 0x20000
    v_and_b32 v232, 15, v235
    v_lshlrev_b32 v232, 10, v232
    v_lshrrev_b32 v233, 5, v235
    v_lshl_add_u32 v232, v233, 4, v232
    v_bfe_u32 v233, v235, 4, 1
    v_lshl_add_u32 v249, v233, 5, v232
    s_lshl_b32 s32, s18, 16
    s_add_u32 s95, s95, s32
    s_lshl_b32 s32, s22, 15
    s_add_u32 s95, s95, s32
    s_lshl_b32 s32, s23, 6
    s_add_u32 s95, s95, s32
    s_add_u32 s32, s33, 0
    v_add_u32 v250, s32, v245
    v_xor_b32 v251, 0x2000, v250
    s_mov_b32 s52, s30
    s_mov_b32 s53, s31
    s_mov_b32 s54, 7340032
    s_mov_b32 s55, 0x20000
    s_barrier
    s_mov_b32 s40, s4
    s_mov_b32 s41, s5
    s_mov_b32 s42, 0x200000
    s_mov_b32 s43, 0x20000
    v_lshrrev_b32 v232, 3, v235
    v_lshlrev_b32 v232, 10, v232
    v_and_b32 v233, 0x70, v245
    v_add_u32 v232, v232, v233
    s_add_u32 s32, s84, 0
    s_and_b32 s32, s32, 3
    s_lshl2_add_u32 s32, s16, s32
    s_lshl2_add_u32 s32, s32, s21
    s_lshl_b32 s32, s32, 14
    s_add_u32 s32, s32, 384
    buffer_load_dwordx4 v[160:163], v232, s[40:43], s32 offen
    s_add_u32 s32, s32, 8192
    buffer_load_dwordx4 v[164:167], v232, s[40:43], s32 offen
    s_add_u32 s32, s32, 8192
    s_cmp_eq_u32 s22, 0
    s_cselect_b32 s40, s6, s8
    s_cselect_b32 s41, s7, s9
    s_mov_b32 s42, 1835008
    s_mov_b32 s43, 0x20000
    v_min_u32 v232, 880, v245
    s_lshl1_add_u32 s32, s35, s23
    s_lshl_b32 s32, s32, 3
    s_add_u32 s32, s32, 192
    s_mul_i32 s32, s32, 3584
    s_lshr_b32 s96, s14, 1
    s_mul_i32 s96, s96, 896
    s_add_u32 s32, s32, s96
    buffer_load_dwordx4 v[128:131], v232, s[40:43], s32 offen
    s_add_u32 s32, s32, 3584
    buffer_load_dwordx4 v[132:135], v232, s[40:43], s32 offen
    s_add_u32 s32, s32, 3584
    buffer_load_dwordx4 v[136:139], v232, s[40:43], s32 offen
    s_add_u32 s32, s32, 3584
    buffer_load_dwordx4 v[140:143], v232, s[40:43], s32 offen
    s_add_u32 s32, s32, 3584
    buffer_load_dwordx4 v[144:147], v232, s[40:43], s32 offen
    s_add_u32 s32, s32, 3584
    buffer_load_dwordx4 v[148:151], v232, s[40:43], s32 offen
    s_add_u32 s32, s32, 3584
    buffer_load_dwordx4 v[152:155], v232, s[40:43], s32 offen
    s_add_u32 s32, s32, 3584
    buffer_load_dwordx4 v[156:159], v232, s[40:43], s32 offen
    s_add_u32 s32, s32, 3584
    s_sub_u32 s32, s2, 224
    s_lshl2_add_u32 s32, s32, s21
    s_mul_i32 s32, s32, 14336
    buffer_load_dwordx4 v[0:3], v245, s[48:51], s32 offen offset:0
    buffer_load_dwordx4 v[4:7], v245, s[48:51], s32 offen offset:1024
    buffer_load_dwordx4 v[8:11], v245, s[48:51], s32 offen offset:2048
    buffer_load_dwordx4 v[12:15], v245, s[48:51], s32 offen offset:3072
    s_add_u32 s32, s32, 4096
    buffer_load_dwordx4 v[16:19], v245, s[48:51], s32 offen offset:0
    buffer_load_dwordx4 v[20:23], v245, s[48:51], s32 offen offset:1024
    buffer_load_dwordx4 v[24:27], v245, s[48:51], s32 offen offset:2048
    buffer_load_dwordx4 v[28:31], v245, s[48:51], s32 offen offset:3072
    s_add_u32 s32, s32, 4096
    buffer_load_dwordx4 v[32:35], v245, s[48:51], s32 offen offset:0
    buffer_load_dwordx4 v[36:39], v245, s[48:51], s32 offen offset:1024
    buffer_load_dwordx4 v[40:43], v245, s[48:51], s32 offen offset:2048
    buffer_load_dwordx4 v[44:47], v245, s[48:51], s32 offen offset:3072
    s_add_u32 s32, s32, 4096
    buffer_load_dwordx4 v[48:51], v245, s[48:51], s32 offen offset:0
    buffer_load_dwordx4 v[52:55], v245, s[48:51], s32 offen offset:1024
    s_mov_b32 s40, s4
    s_mov_b32 s41, s5
    s_mov_b32 s42, 0x200000
    s_mov_b32 s43, 0x20000
    v_lshrrev_b32 v232, 3, v235
    v_lshlrev_b32 v232, 10, v232
    v_and_b32 v233, 0x70, v245
    v_add_u32 v232, v232, v233
    s_lshl2_add_u32 s32, s16, s21
    s_lshl_b32 s32, s32, 16
    s_add_u32 s32, s32, 384
    buffer_load_dwordx4 v[64:67], v232, s[40:43], s32 offen
    s_add_u32 s32, s32, 8192
    buffer_load_dwordx4 v[68:71], v232, s[40:43], s32 offen
    s_add_u32 s32, s32, 8192
    buffer_load_dwordx4 v[72:75], v232, s[40:43], s32 offen
    s_add_u32 s32, s32, 8192
    buffer_load_dwordx4 v[76:79], v232, s[40:43], s32 offen
    s_add_u32 s32, s32, 8192
    buffer_load_dwordx4 v[80:83], v232, s[40:43], s32 offen
    s_add_u32 s32, s32, 8192
    buffer_load_dwordx4 v[84:87], v232, s[40:43], s32 offen
    s_add_u32 s32, s32, 8192
    buffer_load_dwordx4 v[88:91], v232, s[40:43], s32 offen
    s_add_u32 s32, s32, 8192
    buffer_load_dwordx4 v[92:95], v232, s[40:43], s32 offen
    s_add_u32 s32, s32, 8192
    s_waitcnt vmcnt(0)
    s_barrier
    s_setprio 1
    s_barrier
    buffer_load_dwordx4 v[0:3], v180, s[52:55], s60 offen offset:0 sc1
    buffer_load_dwordx4 v[4:7], v180, s[52:55], s60 offen offset:256 sc1
    buffer_load_dwordx4 v[8:11], v180, s[52:55], s60 offen offset:2048 sc1
    buffer_load_dwordx4 v[12:15], v180, s[52:55], s60 offen offset:2304 sc1
    buffer_load_dwordx4 v[16:19], v180, s[52:55], s61 offen offset:0 sc1
    buffer_load_dwordx4 v[20:23], v180, s[52:55], s61 offen offset:256 sc1
    buffer_load_dwordx4 v[24:27], v180, s[52:55], s61 offen offset:2048 sc1
    buffer_load_dwordx4 v[28:31], v180, s[52:55], s61 offen offset:2304 sc1
    buffer_load_dwordx4 v[32:35], v180, s[52:55], s62 offen offset:0 sc1
    buffer_load_dwordx4 v[36:39], v180, s[52:55], s62 offen offset:256 sc1
    buffer_load_dwordx4 v[40:43], v180, s[52:55], s62 offen offset:2048 sc1
    buffer_load_dwordx4 v[44:47], v180, s[52:55], s62 offen offset:2304 sc1
    s_barrier
    buffer_load_dwordx4 v[48:51], v180, s[52:55], s63 offen offset:0 sc1
    buffer_load_dwordx4 v[52:55], v180, s[52:55], s63 offen offset:256 sc1
    buffer_load_dwordx4 v[56:59], v180, s[52:55], s63 offen offset:2048 sc1
    buffer_load_dwordx4 v[60:63], v180, s[52:55], s63 offen offset:2304 sc1
    buffer_load_dwordx4 v[64:67], v180, s[52:55], s64 offen offset:0 sc1
    buffer_load_dwordx4 v[68:71], v180, s[52:55], s64 offen offset:256 sc1
    buffer_load_dwordx4 v[72:75], v180, s[52:55], s64 offen offset:2048 sc1
    buffer_load_dwordx4 v[76:79], v180, s[52:55], s64 offen offset:2304 sc1
    buffer_load_dwordx4 v[80:83], v180, s[52:55], s65 offen offset:0 sc1
    buffer_load_dwordx4 v[84:87], v180, s[52:55], s65 offen offset:256 sc1
    buffer_load_dwordx4 v[88:91], v180, s[52:55], s65 offen offset:2048 sc1
    buffer_load_dwordx4 v[92:95], v180, s[52:55], s65 offen offset:2304 sc1
    buffer_load_dwordx4 v[96:99], v180, s[52:55], s66 offen offset:0 sc1
    buffer_load_dwordx4 v[100:103], v180, s[52:55], s66 offen offset:256 sc1
    buffer_load_dwordx4 v[104:107], v180, s[52:55], s66 offen offset:2048 sc1
    buffer_load_dwordx4 v[108:111], v180, s[52:55], s66 offen offset:2304 sc1
    s_barrier
    ds_read_b64_tr_b16 v[208:209], v176 offset:0
    ds_read_b64_tr_b16 v[210:211], v176 offset:512
    ds_read_b64_tr_b16 v[212:213], v177 offset:0
    ds_read_b64_tr_b16 v[214:215], v177 offset:512
    ds_read_b64_tr_b16 v[216:217], v178 offset:0
    ds_read_b64_tr_b16 v[218:219], v178 offset:512
    ds_read_b64_tr_b16 v[220:221], v179 offset:0
    ds_read_b64_tr_b16 v[222:223], v179 offset:512
    ds_read_b64_tr_b16 v[224:225], v176 offset:4096
    ds_read_b64_tr_b16 v[226:227], v176 offset:4608
    ds_read_b64_tr_b16 v[228:229], v177 offset:4096
    ds_read_b64_tr_b16 v[230:231], v177 offset:4608
    s_waitcnt vmcnt(26) lgkmcnt(8)
    v_mfma_f32_16x16x32_bf16 v[160:163], v[208:211], v[0:3], 0
    v_mfma_f32_16x16x32_bf16 v[164:167], v[208:211], v[4:7], 0
    v_mfma_f32_16x16x32_bf16 v[168:171], v[212:215], v[0:3], 0
    ds_read_b64_tr_b16 v[208:209], v178 offset:4096
    v_mfma_f32_16x16x32_bf16 v[172:175], v[212:215], v[4:7], 0
    ds_read_b64_tr_b16 v[210:211], v178 offset:4608
    s_waitcnt lgkmcnt(6)
    v_mfma_f32_16x16x32_bf16 v[128:131], v[216:219], v[0:3], 0
    ds_read_b64_tr_b16 v[212:213], v179 offset:4096
    v_mfma_f32_16x16x32_bf16 v[132:135], v[216:219], v[4:7], 0
    ds_read_b64_tr_b16 v[214:215], v179 offset:4608
    v_mfma_f32_16x16x32_bf16 v[136:139], v[220:223], v[0:3], 0
    v_add_u32 v176, 0x4000, v176
    ds_read_b64_tr_b16 v[216:217], v176 offset:0
    v_mfma_f32_16x16x32_bf16 v[140:143], v[220:223], v[4:7], 0
    ds_read_b64_tr_b16 v[218:219], v176 offset:512
    s_waitcnt vmcnt(24) lgkmcnt(6)
    v_mfma_f32_16x16x32_bf16 v[160:163], v[224:227], v[8:11], v[160:163]
    v_add_u32 v177, 0x4000, v177
    ds_read_b64_tr_b16 v[220:221], v177 offset:0
    v_mfma_f32_16x16x32_bf16 v[164:167], v[224:227], v[12:15], v[164:167]
    ds_read_b64_tr_b16 v[222:223], v177 offset:512
    v_mfma_f32_16x16x32_bf16 v[168:171], v[228:231], v[8:11], v[168:171]
    v_add_u32 v178, 0x4000, v178
    ds_read_b64_tr_b16 v[224:225], v178 offset:0
    v_mfma_f32_16x16x32_bf16 v[172:175], v[228:231], v[12:15], v[172:175]
    ds_read_b64_tr_b16 v[226:227], v178 offset:512
    s_waitcnt lgkmcnt(6)
    v_mfma_f32_16x16x32_bf16 v[128:131], v[208:211], v[8:11], v[128:131]
    v_add_u32 v179, 0x4000, v179
    ds_read_b64_tr_b16 v[228:229], v179 offset:0
    v_mfma_f32_16x16x32_bf16 v[132:135], v[208:211], v[12:15], v[132:135]
    ds_read_b64_tr_b16 v[230:231], v179 offset:512
    v_mfma_f32_16x16x32_bf16 v[136:139], v[212:215], v[8:11], v[136:139]
    ds_read_b64_tr_b16 v[208:209], v176 offset:4096
    v_mfma_f32_16x16x32_bf16 v[140:143], v[212:215], v[12:15], v[140:143]
    ds_read_b64_tr_b16 v[210:211], v176 offset:4608
    s_waitcnt vmcnt(22) lgkmcnt(6)
    v_mfma_f32_16x16x32_bf16 v[160:163], v[216:219], v[16:19], v[160:163]
    ds_read_b64_tr_b16 v[212:213], v177 offset:4096
    v_mfma_f32_16x16x32_bf16 v[164:167], v[216:219], v[20:23], v[164:167]
    ds_read_b64_tr_b16 v[214:215], v177 offset:4608
    v_mfma_f32_16x16x32_bf16 v[168:171], v[220:223], v[16:19], v[168:171]
    ds_read_b64_tr_b16 v[216:217], v178 offset:4096
    v_mfma_f32_16x16x32_bf16 v[172:175], v[220:223], v[20:23], v[172:175]
    ds_read_b64_tr_b16 v[218:219], v178 offset:4608
    s_waitcnt lgkmcnt(6)
    v_mfma_f32_16x16x32_bf16 v[128:131], v[224:227], v[16:19], v[128:131]
    ds_read_b64_tr_b16 v[220:221], v179 offset:4096
    v_mfma_f32_16x16x32_bf16 v[132:135], v[224:227], v[20:23], v[132:135]
    ds_read_b64_tr_b16 v[222:223], v179 offset:4608
    v_mfma_f32_16x16x32_bf16 v[136:139], v[228:231], v[16:19], v[136:139]
    v_add_u32 v176, 0x4000, v176
    ds_read_b64_tr_b16 v[224:225], v176 offset:0
    v_mfma_f32_16x16x32_bf16 v[140:143], v[228:231], v[20:23], v[140:143]
    ds_read_b64_tr_b16 v[226:227], v176 offset:512
    s_waitcnt vmcnt(20) lgkmcnt(6)
    v_mfma_f32_16x16x32_bf16 v[160:163], v[208:211], v[24:27], v[160:163]
    v_add_u32 v177, 0x4000, v177
    ds_read_b64_tr_b16 v[228:229], v177 offset:0
    v_mfma_f32_16x16x32_bf16 v[164:167], v[208:211], v[28:31], v[164:167]
    ds_read_b64_tr_b16 v[230:231], v177 offset:512
    v_mfma_f32_16x16x32_bf16 v[168:171], v[212:215], v[24:27], v[168:171]
    v_add_u32 v178, 0x4000, v178
    ds_read_b64_tr_b16 v[208:209], v178 offset:0
    v_mfma_f32_16x16x32_bf16 v[172:175], v[212:215], v[28:31], v[172:175]
    ds_read_b64_tr_b16 v[210:211], v178 offset:512
    s_waitcnt lgkmcnt(6)
    v_mfma_f32_16x16x32_bf16 v[128:131], v[216:219], v[24:27], v[128:131]
    v_add_u32 v179, 0x4000, v179
    ds_read_b64_tr_b16 v[212:213], v179 offset:0
    v_mfma_f32_16x16x32_bf16 v[132:135], v[216:219], v[28:31], v[132:135]
    ds_read_b64_tr_b16 v[214:215], v179 offset:512
    v_mfma_f32_16x16x32_bf16 v[136:139], v[220:223], v[24:27], v[136:139]
    ds_read_b64_tr_b16 v[216:217], v176 offset:4096
    v_mfma_f32_16x16x32_bf16 v[140:143], v[220:223], v[28:31], v[140:143]
    ds_read_b64_tr_b16 v[218:219], v176 offset:4608
    s_barrier
    s_waitcnt vmcnt(18) lgkmcnt(6)
    v_mfma_f32_16x16x32_bf16 v[160:163], v[224:227], v[32:35], v[160:163]
    ds_read_b64_tr_b16 v[220:221], v177 offset:4096
    v_mfma_f32_16x16x32_bf16 v[164:167], v[224:227], v[36:39], v[164:167]
    ds_read_b64_tr_b16 v[222:223], v177 offset:4608
    v_mfma_f32_16x16x32_bf16 v[168:171], v[228:231], v[32:35], v[168:171]
    ds_read_b64_tr_b16 v[224:225], v178 offset:4096
    v_mfma_f32_16x16x32_bf16 v[172:175], v[228:231], v[36:39], v[172:175]
    ds_read_b64_tr_b16 v[226:227], v178 offset:4608
    s_waitcnt lgkmcnt(6)
    v_mfma_f32_16x16x32_bf16 v[128:131], v[208:211], v[32:35], v[128:131]
    ds_read_b64_tr_b16 v[228:229], v179 offset:4096
    v_mfma_f32_16x16x32_bf16 v[132:135], v[208:211], v[36:39], v[132:135]
    ds_read_b64_tr_b16 v[230:231], v179 offset:4608
    v_mfma_f32_16x16x32_bf16 v[136:139], v[212:215], v[32:35], v[136:139]
    v_add_u32 v176, 0x4000, v176
    ds_read_b64_tr_b16 v[208:209], v176 offset:0
    v_mfma_f32_16x16x32_bf16 v[140:143], v[212:215], v[36:39], v[140:143]
    ds_read_b64_tr_b16 v[210:211], v176 offset:512
    s_waitcnt vmcnt(16) lgkmcnt(6)
    v_mfma_f32_16x16x32_bf16 v[160:163], v[216:219], v[40:43], v[160:163]
    v_add_u32 v177, 0x4000, v177
    ds_read_b64_tr_b16 v[212:213], v177 offset:0
    v_mfma_f32_16x16x32_bf16 v[164:167], v[216:219], v[44:47], v[164:167]
    ds_read_b64_tr_b16 v[214:215], v177 offset:512
    v_mfma_f32_16x16x32_bf16 v[168:171], v[220:223], v[40:43], v[168:171]
    v_add_u32 v178, 0x4000, v178
    ds_read_b64_tr_b16 v[216:217], v178 offset:0
    v_mfma_f32_16x16x32_bf16 v[172:175], v[220:223], v[44:47], v[172:175]
    ds_read_b64_tr_b16 v[218:219], v178 offset:512
    s_waitcnt lgkmcnt(6)
    v_mfma_f32_16x16x32_bf16 v[128:131], v[224:227], v[40:43], v[128:131]
    v_add_u32 v179, 0x4000, v179
    ds_read_b64_tr_b16 v[220:221], v179 offset:0
    v_mfma_f32_16x16x32_bf16 v[132:135], v[224:227], v[44:47], v[132:135]
    ds_read_b64_tr_b16 v[222:223], v179 offset:512
    v_mfma_f32_16x16x32_bf16 v[136:139], v[228:231], v[40:43], v[136:139]
    ds_read_b64_tr_b16 v[224:225], v176 offset:4096
    v_mfma_f32_16x16x32_bf16 v[140:143], v[228:231], v[44:47], v[140:143]
    ds_read_b64_tr_b16 v[226:227], v176 offset:4608
    s_waitcnt vmcnt(14) lgkmcnt(6)
    v_mfma_f32_16x16x32_bf16 v[160:163], v[208:211], v[48:51], v[160:163]
    ds_read_b64_tr_b16 v[228:229], v177 offset:4096
    v_mfma_f32_16x16x32_bf16 v[164:167], v[208:211], v[52:55], v[164:167]
    ds_read_b64_tr_b16 v[230:231], v177 offset:4608
    v_mfma_f32_16x16x32_bf16 v[168:171], v[212:215], v[48:51], v[168:171]
    ds_read_b64_tr_b16 v[208:209], v178 offset:4096
    v_mfma_f32_16x16x32_bf16 v[172:175], v[212:215], v[52:55], v[172:175]
    ds_read_b64_tr_b16 v[210:211], v178 offset:4608
    s_waitcnt lgkmcnt(6)
    v_mfma_f32_16x16x32_bf16 v[128:131], v[216:219], v[48:51], v[128:131]
    ds_read_b64_tr_b16 v[212:213], v179 offset:4096
    v_mfma_f32_16x16x32_bf16 v[132:135], v[216:219], v[52:55], v[132:135]
    ds_read_b64_tr_b16 v[214:215], v179 offset:4608
    v_mfma_f32_16x16x32_bf16 v[136:139], v[220:223], v[48:51], v[136:139]
    v_add_u32 v176, 0x8000, v176
    ds_read_b64_tr_b16 v[216:217], v176 offset:0
    v_mfma_f32_16x16x32_bf16 v[140:143], v[220:223], v[52:55], v[140:143]
    ds_read_b64_tr_b16 v[218:219], v176 offset:512
    s_waitcnt vmcnt(12) lgkmcnt(6)
    v_mfma_f32_16x16x32_bf16 v[160:163], v[224:227], v[56:59], v[160:163]
    v_add_u32 v177, 0x8000, v177
    ds_read_b64_tr_b16 v[220:221], v177 offset:0
    v_mfma_f32_16x16x32_bf16 v[164:167], v[224:227], v[60:63], v[164:167]
    ds_read_b64_tr_b16 v[222:223], v177 offset:512
    v_mfma_f32_16x16x32_bf16 v[168:171], v[228:231], v[56:59], v[168:171]
    v_add_u32 v178, 0x8000, v178
    ds_read_b64_tr_b16 v[224:225], v178 offset:0
    v_mfma_f32_16x16x32_bf16 v[172:175], v[228:231], v[60:63], v[172:175]
    ds_read_b64_tr_b16 v[226:227], v178 offset:512
    s_waitcnt lgkmcnt(6)
    v_mfma_f32_16x16x32_bf16 v[128:131], v[208:211], v[56:59], v[128:131]
    v_add_u32 v179, 0x8000, v179
    ds_read_b64_tr_b16 v[228:229], v179 offset:0
    v_mfma_f32_16x16x32_bf16 v[132:135], v[208:211], v[60:63], v[132:135]
    ds_read_b64_tr_b16 v[230:231], v179 offset:512
    v_mfma_f32_16x16x32_bf16 v[136:139], v[212:215], v[56:59], v[136:139]
    ds_read_b64_tr_b16 v[208:209], v176 offset:4096
    v_mfma_f32_16x16x32_bf16 v[140:143], v[212:215], v[60:63], v[140:143]
    ds_read_b64_tr_b16 v[210:211], v176 offset:4608
    s_barrier
    s_waitcnt vmcnt(10) lgkmcnt(6)
    v_mfma_f32_16x16x32_bf16 v[160:163], v[216:219], v[64:67], v[160:163]
    ds_read_b64_tr_b16 v[212:213], v177 offset:4096
    v_mfma_f32_16x16x32_bf16 v[164:167], v[216:219], v[68:71], v[164:167]
    ds_read_b64_tr_b16 v[214:215], v177 offset:4608
    v_mfma_f32_16x16x32_bf16 v[168:171], v[220:223], v[64:67], v[168:171]
    ds_read_b64_tr_b16 v[216:217], v178 offset:4096
    buffer_load_dwordx4 v[112:115], v180, s[52:55], s67 offen offset:0 sc1
    v_mfma_f32_16x16x32_bf16 v[172:175], v[220:223], v[68:71], v[172:175]
    ds_read_b64_tr_b16 v[218:219], v178 offset:4608
    s_waitcnt lgkmcnt(6)
    v_mfma_f32_16x16x32_bf16 v[128:131], v[224:227], v[64:67], v[128:131]
    ds_read_b64_tr_b16 v[220:221], v179 offset:4096
    v_mfma_f32_16x16x32_bf16 v[132:135], v[224:227], v[68:71], v[132:135]
    ds_read_b64_tr_b16 v[222:223], v179 offset:4608
    v_mfma_f32_16x16x32_bf16 v[136:139], v[228:231], v[64:67], v[136:139]
    v_add_u32 v176, 0xffffc000, v176
    ds_read_b64_tr_b16 v[224:225], v176 offset:0
    buffer_load_dwordx4 v[116:119], v180, s[52:55], s67 offen offset:256 sc1
    v_mfma_f32_16x16x32_bf16 v[140:143], v[228:231], v[68:71], v[140:143]
    ds_read_b64_tr_b16 v[226:227], v176 offset:512
    s_waitcnt vmcnt(10) lgkmcnt(6)
    v_mfma_f32_16x16x32_bf16 v[160:163], v[208:211], v[72:75], v[160:163]
    v_add_u32 v177, 0xffffc000, v177
    ds_read_b64_tr_b16 v[228:229], v177 offset:0
    v_mfma_f32_16x16x32_bf16 v[164:167], v[208:211], v[76:79], v[164:167]
    ds_read_b64_tr_b16 v[230:231], v177 offset:512
    v_mfma_f32_16x16x32_bf16 v[168:171], v[212:215], v[72:75], v[168:171]
    v_add_u32 v178, 0xffffc000, v178
    ds_read_b64_tr_b16 v[208:209], v178 offset:0
    buffer_load_dwordx4 v[120:123], v180, s[52:55], s67 offen offset:2048 sc1
    v_mfma_f32_16x16x32_bf16 v[172:175], v[212:215], v[76:79], v[172:175]
    ds_read_b64_tr_b16 v[210:211], v178 offset:512
    s_waitcnt lgkmcnt(6)
    v_mfma_f32_16x16x32_bf16 v[128:131], v[216:219], v[72:75], v[128:131]
    v_add_u32 v179, 0xffffc000, v179
    ds_read_b64_tr_b16 v[212:213], v179 offset:0
    v_mfma_f32_16x16x32_bf16 v[132:135], v[216:219], v[76:79], v[132:135]
    ds_read_b64_tr_b16 v[214:215], v179 offset:512
    v_mfma_f32_16x16x32_bf16 v[136:139], v[220:223], v[72:75], v[136:139]
    ds_read_b64_tr_b16 v[216:217], v176 offset:4096
    buffer_load_dwordx4 v[124:127], v180, s[52:55], s67 offen offset:2304 sc1
    v_mfma_f32_16x16x32_bf16 v[140:143], v[220:223], v[76:79], v[140:143]
    ds_read_b64_tr_b16 v[218:219], v176 offset:4608
    s_waitcnt vmcnt(10) lgkmcnt(6)
    v_mfma_f32_16x16x32_bf16 v[160:163], v[224:227], v[80:83], v[160:163]
    ds_read_b64_tr_b16 v[220:221], v177 offset:4096
    v_mfma_f32_16x16x32_bf16 v[164:167], v[224:227], v[84:87], v[164:167]
    ds_read_b64_tr_b16 v[222:223], v177 offset:4608
    v_mfma_f32_16x16x32_bf16 v[168:171], v[228:231], v[80:83], v[168:171]
    ds_read_b64_tr_b16 v[224:225], v178 offset:4096
    buffer_load_dwordx4 v[0:3], v180, s[52:55], s68 offen offset:0 sc1
    v_mfma_f32_16x16x32_bf16 v[172:175], v[228:231], v[84:87], v[172:175]
    ds_read_b64_tr_b16 v[226:227], v178 offset:4608
    s_waitcnt lgkmcnt(6)
    v_mfma_f32_16x16x32_bf16 v[128:131], v[208:211], v[80:83], v[128:131]
    ds_read_b64_tr_b16 v[228:229], v179 offset:4096
    v_mfma_f32_16x16x32_bf16 v[132:135], v[208:211], v[84:87], v[132:135]
    ds_read_b64_tr_b16 v[230:231], v179 offset:4608
    v_mfma_f32_16x16x32_bf16 v[136:139], v[212:215], v[80:83], v[136:139]
    v_add_u32 v176, 0x8000, v176
    ds_read_b64_tr_b16 v[208:209], v176 offset:0
    buffer_load_dwordx4 v[4:7], v180, s[52:55], s68 offen offset:256 sc1
    v_mfma_f32_16x16x32_bf16 v[140:143], v[212:215], v[84:87], v[140:143]
    ds_read_b64_tr_b16 v[210:211], v176 offset:512
    s_waitcnt vmcnt(10) lgkmcnt(6)
    v_mfma_f32_16x16x32_bf16 v[160:163], v[216:219], v[88:91], v[160:163]
    v_add_u32 v177, 0x8000, v177
    ds_read_b64_tr_b16 v[212:213], v177 offset:0
    v_mfma_f32_16x16x32_bf16 v[164:167], v[216:219], v[92:95], v[164:167]
    ds_read_b64_tr_b16 v[214:215], v177 offset:512
    v_mfma_f32_16x16x32_bf16 v[168:171], v[220:223], v[88:91], v[168:171]
    v_add_u32 v178, 0x8000, v178
    ds_read_b64_tr_b16 v[216:217], v178 offset:0
    buffer_load_dwordx4 v[8:11], v180, s[52:55], s68 offen offset:2048 sc1
    v_mfma_f32_16x16x32_bf16 v[172:175], v[220:223], v[92:95], v[172:175]
    ds_read_b64_tr_b16 v[218:219], v178 offset:512
    s_waitcnt lgkmcnt(6)
    v_mfma_f32_16x16x32_bf16 v[128:131], v[224:227], v[88:91], v[128:131]
    v_add_u32 v179, 0x8000, v179
    ds_read_b64_tr_b16 v[220:221], v179 offset:0
    v_mfma_f32_16x16x32_bf16 v[132:135], v[224:227], v[92:95], v[132:135]
    ds_read_b64_tr_b16 v[222:223], v179 offset:512
    v_mfma_f32_16x16x32_bf16 v[136:139], v[228:231], v[88:91], v[136:139]
    ds_read_b64_tr_b16 v[224:225], v176 offset:4096
    buffer_load_dwordx4 v[12:15], v180, s[52:55], s68 offen offset:2304 sc1
    v_mfma_f32_16x16x32_bf16 v[140:143], v[228:231], v[92:95], v[140:143]
    ds_read_b64_tr_b16 v[226:227], v176 offset:4608
    s_barrier
    s_waitcnt vmcnt(10) lgkmcnt(6)
    v_mfma_f32_16x16x32_bf16 v[160:163], v[208:211], v[96:99], v[160:163]
    ds_read_b64_tr_b16 v[228:229], v177 offset:4096
    v_mfma_f32_16x16x32_bf16 v[164:167], v[208:211], v[100:103], v[164:167]
    ds_read_b64_tr_b16 v[230:231], v177 offset:4608
    v_mfma_f32_16x16x32_bf16 v[168:171], v[212:215], v[96:99], v[168:171]
    ds_read_b64_tr_b16 v[208:209], v178 offset:4096
    buffer_load_dwordx4 v[16:19], v180, s[52:55], s69 offen offset:0 sc1
    v_mfma_f32_16x16x32_bf16 v[172:175], v[212:215], v[100:103], v[172:175]
    ds_read_b64_tr_b16 v[210:211], v178 offset:4608
    s_waitcnt lgkmcnt(6)
    v_mfma_f32_16x16x32_bf16 v[128:131], v[216:219], v[96:99], v[128:131]
    ds_read_b64_tr_b16 v[212:213], v179 offset:4096
    v_mfma_f32_16x16x32_bf16 v[132:135], v[216:219], v[100:103], v[132:135]
    ds_read_b64_tr_b16 v[214:215], v179 offset:4608
    v_mfma_f32_16x16x32_bf16 v[136:139], v[220:223], v[96:99], v[136:139]
    v_add_u32 v176, 0xfffe0000, v176
    ds_read_b64_tr_b16 v[216:217], v176 offset:0
    buffer_load_dwordx4 v[20:23], v180, s[52:55], s69 offen offset:256 sc1
    v_mfma_f32_16x16x32_bf16 v[140:143], v[220:223], v[100:103], v[140:143]
    ds_read_b64_tr_b16 v[218:219], v176 offset:512
    s_waitcnt vmcnt(10) lgkmcnt(6)
    v_mfma_f32_16x16x32_bf16 v[160:163], v[224:227], v[104:107], v[160:163]
    v_add_u32 v177, 0xfffe0000, v177
    ds_read_b64_tr_b16 v[220:221], v177 offset:0
    v_mfma_f32_16x16x32_bf16 v[164:167], v[224:227], v[108:111], v[164:167]
    ds_read_b64_tr_b16 v[222:223], v177 offset:512
    v_mfma_f32_16x16x32_bf16 v[168:171], v[228:231], v[104:107], v[168:171]
    v_add_u32 v178, 0xfffe0000, v178
    ds_read_b64_tr_b16 v[224:225], v178 offset:0
    buffer_load_dwordx4 v[24:27], v180, s[52:55], s69 offen offset:2048 sc1
    v_mfma_f32_16x16x32_bf16 v[172:175], v[228:231], v[108:111], v[172:175]
    ds_read_b64_tr_b16 v[226:227], v178 offset:512
    s_waitcnt lgkmcnt(6)
    v_mfma_f32_16x16x32_bf16 v[128:131], v[208:211], v[104:107], v[128:131]
    v_add_u32 v179, 0xfffe0000, v179
    ds_read_b64_tr_b16 v[228:229], v179 offset:0
    v_mfma_f32_16x16x32_bf16 v[132:135], v[208:211], v[108:111], v[132:135]
    ds_read_b64_tr_b16 v[230:231], v179 offset:512
    v_mfma_f32_16x16x32_bf16 v[136:139], v[212:215], v[104:107], v[136:139]
    ds_read_b64_tr_b16 v[208:209], v176 offset:4096
    buffer_load_dwordx4 v[28:31], v180, s[52:55], s69 offen offset:2304 sc1
    v_mfma_f32_16x16x32_bf16 v[140:143], v[212:215], v[108:111], v[140:143]
    ds_read_b64_tr_b16 v[210:211], v176 offset:4608
    s_waitcnt vmcnt(10) lgkmcnt(6)
    v_mfma_f32_16x16x32_bf16 v[160:163], v[216:219], v[112:115], v[160:163]
    ds_read_b64_tr_b16 v[212:213], v177 offset:4096
    v_mfma_f32_16x16x32_bf16 v[164:167], v[216:219], v[116:119], v[164:167]
    ds_read_b64_tr_b16 v[214:215], v177 offset:4608
    v_mfma_f32_16x16x32_bf16 v[168:171], v[220:223], v[112:115], v[168:171]
    ds_read_b64_tr_b16 v[216:217], v178 offset:4096
    v_mfma_f32_16x16x32_bf16 v[172:175], v[220:223], v[116:119], v[172:175]
    ds_read_b64_tr_b16 v[218:219], v178 offset:4608
    s_waitcnt lgkmcnt(6)
    v_mfma_f32_16x16x32_bf16 v[128:131], v[224:227], v[112:115], v[128:131]
    ds_read_b64_tr_b16 v[220:221], v179 offset:4096
    v_mfma_f32_16x16x32_bf16 v[132:135], v[224:227], v[116:119], v[132:135]
    ds_read_b64_tr_b16 v[222:223], v179 offset:4608
    v_mfma_f32_16x16x32_bf16 v[136:139], v[228:231], v[112:115], v[136:139]
    v_add_u32 v176, 0x4000, v176
    ds_read_b64_tr_b16 v[224:225], v176 offset:0
    v_mfma_f32_16x16x32_bf16 v[140:143], v[228:231], v[116:119], v[140:143]
    ds_read_b64_tr_b16 v[226:227], v176 offset:512
    s_waitcnt vmcnt(8) lgkmcnt(6)
    v_mfma_f32_16x16x32_bf16 v[160:163], v[208:211], v[120:123], v[160:163]
    v_add_u32 v177, 0x4000, v177
    ds_read_b64_tr_b16 v[228:229], v177 offset:0
    v_mfma_f32_16x16x32_bf16 v[164:167], v[208:211], v[124:127], v[164:167]
    ds_read_b64_tr_b16 v[230:231], v177 offset:512
    v_mfma_f32_16x16x32_bf16 v[168:171], v[212:215], v[120:123], v[168:171]
    v_add_u32 v178, 0x4000, v178
    ds_read_b64_tr_b16 v[208:209], v178 offset:0
    v_mfma_f32_16x16x32_bf16 v[172:175], v[212:215], v[124:127], v[172:175]
    ds_read_b64_tr_b16 v[210:211], v178 offset:512
    s_waitcnt lgkmcnt(6)
    v_mfma_f32_16x16x32_bf16 v[128:131], v[216:219], v[120:123], v[128:131]
    v_add_u32 v179, 0x4000, v179
    ds_read_b64_tr_b16 v[212:213], v179 offset:0
    v_mfma_f32_16x16x32_bf16 v[132:135], v[216:219], v[124:127], v[132:135]
    ds_read_b64_tr_b16 v[214:215], v179 offset:512
    v_mfma_f32_16x16x32_bf16 v[136:139], v[220:223], v[120:123], v[136:139]
    ds_read_b64_tr_b16 v[216:217], v176 offset:4096
    v_mfma_f32_16x16x32_bf16 v[140:143], v[220:223], v[124:127], v[140:143]
    ds_read_b64_tr_b16 v[218:219], v176 offset:4608
    s_barrier
    s_waitcnt vmcnt(6) lgkmcnt(6)
    v_mfma_f32_16x16x32_bf16 v[160:163], v[224:227], v[0:3], v[160:163]
    ds_read_b64_tr_b16 v[220:221], v177 offset:4096
    buffer_load_dwordx4 v[32:35], v180, s[52:55], s70 offen offset:0 sc1
    v_mfma_f32_16x16x32_bf16 v[164:167], v[224:227], v[4:7], v[164:167]
    ds_read_b64_tr_b16 v[222:223], v177 offset:4608
    v_mfma_f32_16x16x32_bf16 v[168:171], v[228:231], v[0:3], v[168:171]
    ds_read_b64_tr_b16 v[224:225], v178 offset:4096
    buffer_load_dwordx4 v[36:39], v180, s[52:55], s70 offen offset:256 sc1
    v_mfma_f32_16x16x32_bf16 v[172:175], v[228:231], v[4:7], v[172:175]
    ds_read_b64_tr_b16 v[226:227], v178 offset:4608
    s_waitcnt lgkmcnt(6)
    v_mfma_f32_16x16x32_bf16 v[128:131], v[208:211], v[0:3], v[128:131]
    ds_read_b64_tr_b16 v[228:229], v179 offset:4096
    buffer_load_dwordx4 v[40:43], v180, s[52:55], s70 offen offset:2048 sc1
    v_mfma_f32_16x16x32_bf16 v[132:135], v[208:211], v[4:7], v[132:135]
    ds_read_b64_tr_b16 v[230:231], v179 offset:4608
    v_mfma_f32_16x16x32_bf16 v[136:139], v[212:215], v[0:3], v[136:139]
    v_add_u32 v176, 0xffff8000, v176
    ds_read_b64_tr_b16 v[208:209], v176 offset:0
    buffer_load_dwordx4 v[44:47], v180, s[52:55], s70 offen offset:2304 sc1
    v_mfma_f32_16x16x32_bf16 v[140:143], v[212:215], v[4:7], v[140:143]
    ds_read_b64_tr_b16 v[210:211], v176 offset:512
    s_waitcnt vmcnt(8) lgkmcnt(6)
    v_mfma_f32_16x16x32_bf16 v[160:163], v[216:219], v[8:11], v[160:163]
    v_add_u32 v177, 0xffff8000, v177
    ds_read_b64_tr_b16 v[212:213], v177 offset:0
    buffer_load_dwordx4 v[48:51], v180, s[52:55], s71 offen offset:0 sc1
    v_mfma_f32_16x16x32_bf16 v[164:167], v[216:219], v[12:15], v[164:167]
    ds_read_b64_tr_b16 v[214:215], v177 offset:512
    v_mfma_f32_16x16x32_bf16 v[168:171], v[220:223], v[8:11], v[168:171]
    v_add_u32 v178, 0xffff8000, v178
    ds_read_b64_tr_b16 v[216:217], v178 offset:0
    buffer_load_dwordx4 v[52:55], v180, s[52:55], s71 offen offset:256 sc1
    v_mfma_f32_16x16x32_bf16 v[172:175], v[220:223], v[12:15], v[172:175]
    ds_read_b64_tr_b16 v[218:219], v178 offset:512
    s_waitcnt lgkmcnt(6)
    v_mfma_f32_16x16x32_bf16 v[128:131], v[224:227], v[8:11], v[128:131]
    v_add_u32 v179, 0xffff8000, v179
    ds_read_b64_tr_b16 v[220:221], v179 offset:0
    buffer_load_dwordx4 v[56:59], v180, s[52:55], s71 offen offset:2048 sc1
    v_mfma_f32_16x16x32_bf16 v[132:135], v[224:227], v[12:15], v[132:135]
    ds_read_b64_tr_b16 v[222:223], v179 offset:512
    v_mfma_f32_16x16x32_bf16 v[136:139], v[228:231], v[8:11], v[136:139]
    ds_read_b64_tr_b16 v[224:225], v176 offset:4096
    buffer_load_dwordx4 v[60:63], v180, s[52:55], s71 offen offset:2304 sc1
    v_mfma_f32_16x16x32_bf16 v[140:143], v[228:231], v[12:15], v[140:143]
    ds_read_b64_tr_b16 v[226:227], v176 offset:4608
    s_waitcnt vmcnt(10) lgkmcnt(6)
    v_mfma_f32_16x16x32_bf16 v[160:163], v[208:211], v[16:19], v[160:163]
    ds_read_b64_tr_b16 v[228:229], v177 offset:4096
    v_mfma_f32_16x16x32_bf16 v[164:167], v[208:211], v[20:23], v[164:167]
    ds_read_b64_tr_b16 v[230:231], v177 offset:4608
    v_mfma_f32_16x16x32_bf16 v[168:171], v[212:215], v[16:19], v[168:171]
    ds_read_b64_tr_b16 v[208:209], v178 offset:4096
    v_mfma_f32_16x16x32_bf16 v[172:175], v[212:215], v[20:23], v[172:175]
    ds_read_b64_tr_b16 v[210:211], v178 offset:4608
    s_waitcnt lgkmcnt(6)
    v_mfma_f32_16x16x32_bf16 v[128:131], v[216:219], v[16:19], v[128:131]
    ds_read_b64_tr_b16 v[212:213], v179 offset:4096
    v_mfma_f32_16x16x32_bf16 v[132:135], v[216:219], v[20:23], v[132:135]
    ds_read_b64_tr_b16 v[214:215], v179 offset:4608
    v_mfma_f32_16x16x32_bf16 v[136:139], v[220:223], v[16:19], v[136:139]
    v_add_u32 v176, s88, v176
    ds_read_b64_tr_b16 v[216:217], v176 offset:0
    v_mfma_f32_16x16x32_bf16 v[140:143], v[220:223], v[20:23], v[140:143]
    ds_read_b64_tr_b16 v[218:219], v176 offset:512
    s_waitcnt vmcnt(8) lgkmcnt(6)
    v_mfma_f32_16x16x32_bf16 v[160:163], v[224:227], v[24:27], v[160:163]
    v_add_u32 v177, s88, v177
    ds_read_b64_tr_b16 v[220:221], v177 offset:0
    v_mfma_f32_16x16x32_bf16 v[164:167], v[224:227], v[28:31], v[164:167]
    ds_read_b64_tr_b16 v[222:223], v177 offset:512
    v_mfma_f32_16x16x32_bf16 v[168:171], v[228:231], v[24:27], v[168:171]
    v_add_u32 v178, s88, v178
    ds_read_b64_tr_b16 v[224:225], v178 offset:0
    v_mfma_f32_16x16x32_bf16 v[172:175], v[228:231], v[28:31], v[172:175]
    ds_read_b64_tr_b16 v[226:227], v178 offset:512
    s_waitcnt lgkmcnt(6)
    v_mfma_f32_16x16x32_bf16 v[128:131], v[208:211], v[24:27], v[128:131]
    v_add_u32 v179, s88, v179
    ds_read_b64_tr_b16 v[228:229], v179 offset:0
    v_mfma_f32_16x16x32_bf16 v[132:135], v[208:211], v[28:31], v[132:135]
    ds_read_b64_tr_b16 v[230:231], v179 offset:512
    v_mfma_f32_16x16x32_bf16 v[136:139], v[212:215], v[24:27], v[136:139]
    ds_read_b64_tr_b16 v[208:209], v176 offset:4096
    v_mfma_f32_16x16x32_bf16 v[140:143], v[212:215], v[28:31], v[140:143]
    ds_read_b64_tr_b16 v[210:211], v176 offset:4608
    s_barrier
    s_waitcnt vmcnt(6) lgkmcnt(6)
    v_mfma_f32_16x16x32_bf16 v[160:163], v[216:219], v[32:35], v[160:163]
    ds_read_b64_tr_b16 v[212:213], v177 offset:4096
    buffer_load_dwordx4 v[64:67], v180, s[52:55], s72 offen offset:0 sc1
    v_mfma_f32_16x16x32_bf16 v[164:167], v[216:219], v[36:39], v[164:167]
    ds_read_b64_tr_b16 v[214:215], v177 offset:4608
    v_mfma_f32_16x16x32_bf16 v[168:171], v[220:223], v[32:35], v[168:171]
    ds_read_b64_tr_b16 v[216:217], v178 offset:4096
    buffer_load_dwordx4 v[68:71], v180, s[52:55], s72 offen offset:256 sc1
    v_mfma_f32_16x16x32_bf16 v[172:175], v[220:223], v[36:39], v[172:175]
    ds_read_b64_tr_b16 v[218:219], v178 offset:4608
    s_waitcnt lgkmcnt(6)
    v_mfma_f32_16x16x32_bf16 v[128:131], v[224:227], v[32:35], v[128:131]
    ds_read_b64_tr_b16 v[220:221], v179 offset:4096
    buffer_load_dwordx4 v[72:75], v180, s[52:55], s72 offen offset:2048 sc1
    v_mfma_f32_16x16x32_bf16 v[132:135], v[224:227], v[36:39], v[132:135]
    ds_read_b64_tr_b16 v[222:223], v179 offset:4608
    v_mfma_f32_16x16x32_bf16 v[136:139], v[228:231], v[32:35], v[136:139]
    v_add_u32 v176, s89, v176
    ds_read_b64_tr_b16 v[224:225], v176 offset:0
    buffer_load_dwordx4 v[76:79], v180, s[52:55], s72 offen offset:2304 sc1
    v_mfma_f32_16x16x32_bf16 v[140:143], v[228:231], v[36:39], v[140:143]
    ds_read_b64_tr_b16 v[226:227], v176 offset:512
    s_waitcnt vmcnt(8) lgkmcnt(6)
    v_mfma_f32_16x16x32_bf16 v[160:163], v[208:211], v[40:43], v[160:163]
    v_add_u32 v177, s89, v177
    ds_read_b64_tr_b16 v[228:229], v177 offset:0
    buffer_load_dwordx4 v[80:83], v180, s[52:55], s73 offen offset:0 sc1
    v_mfma_f32_16x16x32_bf16 v[164:167], v[208:211], v[44:47], v[164:167]
    ds_read_b64_tr_b16 v[230:231], v177 offset:512
    v_mfma_f32_16x16x32_bf16 v[168:171], v[212:215], v[40:43], v[168:171]
    v_add_u32 v178, s89, v178
    ds_read_b64_tr_b16 v[208:209], v178 offset:0
    buffer_load_dwordx4 v[84:87], v180, s[52:55], s73 offen offset:256 sc1
    v_mfma_f32_16x16x32_bf16 v[172:175], v[212:215], v[44:47], v[172:175]
    ds_read_b64_tr_b16 v[210:211], v178 offset:512
    s_waitcnt lgkmcnt(6)
    v_mfma_f32_16x16x32_bf16 v[128:131], v[216:219], v[40:43], v[128:131]
    v_add_u32 v179, s89, v179
    ds_read_b64_tr_b16 v[212:213], v179 offset:0
    buffer_load_dwordx4 v[88:91], v180, s[52:55], s73 offen offset:2048 sc1
    v_mfma_f32_16x16x32_bf16 v[132:135], v[216:219], v[44:47], v[132:135]
    ds_read_b64_tr_b16 v[214:215], v179 offset:512
    v_mfma_f32_16x16x32_bf16 v[136:139], v[220:223], v[40:43], v[136:139]
    ds_read_b64_tr_b16 v[216:217], v176 offset:4096
    buffer_load_dwordx4 v[92:95], v180, s[52:55], s73 offen offset:2304 sc1
    v_mfma_f32_16x16x32_bf16 v[140:143], v[220:223], v[44:47], v[140:143]
    ds_read_b64_tr_b16 v[218:219], v176 offset:4608
    s_waitcnt vmcnt(10) lgkmcnt(6)
    v_mfma_f32_16x16x32_bf16 v[160:163], v[224:227], v[48:51], v[160:163]
    ds_read_b64_tr_b16 v[220:221], v177 offset:4096
    v_mfma_f32_16x16x32_bf16 v[164:167], v[224:227], v[52:55], v[164:167]
    ds_read_b64_tr_b16 v[222:223], v177 offset:4608
    v_mfma_f32_16x16x32_bf16 v[168:171], v[228:231], v[48:51], v[168:171]
    ds_read_b64_tr_b16 v[224:225], v178 offset:4096
    v_mfma_f32_16x16x32_bf16 v[172:175], v[228:231], v[52:55], v[172:175]
    ds_read_b64_tr_b16 v[226:227], v178 offset:4608
    s_waitcnt lgkmcnt(6)
    v_mfma_f32_16x16x32_bf16 v[128:131], v[208:211], v[48:51], v[128:131]
    ds_read_b64_tr_b16 v[228:229], v179 offset:4096
    v_mfma_f32_16x16x32_bf16 v[132:135], v[208:211], v[52:55], v[132:135]
    ds_read_b64_tr_b16 v[230:231], v179 offset:4608
    v_mfma_f32_16x16x32_bf16 v[136:139], v[212:215], v[48:51], v[136:139]
    v_add_u32 v176, s90, v176
    ds_read_b64_tr_b16 v[208:209], v176 offset:0
    v_mfma_f32_16x16x32_bf16 v[140:143], v[212:215], v[52:55], v[140:143]
    ds_read_b64_tr_b16 v[210:211], v176 offset:512
    s_waitcnt vmcnt(8) lgkmcnt(6)
    v_mfma_f32_16x16x32_bf16 v[160:163], v[216:219], v[56:59], v[160:163]
    v_add_u32 v177, s90, v177
    ds_read_b64_tr_b16 v[212:213], v177 offset:0
    v_mfma_f32_16x16x32_bf16 v[164:167], v[216:219], v[60:63], v[164:167]
    ds_read_b64_tr_b16 v[214:215], v177 offset:512
    v_mfma_f32_16x16x32_bf16 v[168:171], v[220:223], v[56:59], v[168:171]
    v_add_u32 v178, s90, v178
    ds_read_b64_tr_b16 v[216:217], v178 offset:0
    v_mfma_f32_16x16x32_bf16 v[172:175], v[220:223], v[60:63], v[172:175]
    ds_read_b64_tr_b16 v[218:219], v178 offset:512
    s_waitcnt lgkmcnt(6)
    v_mfma_f32_16x16x32_bf16 v[128:131], v[224:227], v[56:59], v[128:131]
    v_add_u32 v179, s90, v179
    ds_read_b64_tr_b16 v[220:221], v179 offset:0
    v_mfma_f32_16x16x32_bf16 v[132:135], v[224:227], v[60:63], v[132:135]
    ds_read_b64_tr_b16 v[222:223], v179 offset:512
    v_mfma_f32_16x16x32_bf16 v[136:139], v[228:231], v[56:59], v[136:139]
    ds_read_b64_tr_b16 v[224:225], v176 offset:4096
    v_mfma_f32_16x16x32_bf16 v[140:143], v[228:231], v[60:63], v[140:143]
    ds_read_b64_tr_b16 v[226:227], v176 offset:4608
    s_waitcnt vmcnt(6) lgkmcnt(6)
    v_mfma_f32_16x16x32_bf16 v[160:163], v[208:211], v[64:67], v[160:163]
    ds_read_b64_tr_b16 v[228:229], v177 offset:4096
    v_mfma_f32_16x16x32_bf16 v[164:167], v[208:211], v[68:71], v[164:167]
    ds_read_b64_tr_b16 v[230:231], v177 offset:4608
    v_mfma_f32_16x16x32_bf16 v[168:171], v[212:215], v[64:67], v[168:171]
    ds_read_b64_tr_b16 v[208:209], v178 offset:4096
    v_mfma_f32_16x16x32_bf16 v[172:175], v[212:215], v[68:71], v[172:175]
    ds_read_b64_tr_b16 v[210:211], v178 offset:4608
    s_waitcnt lgkmcnt(6)
    v_mfma_f32_16x16x32_bf16 v[128:131], v[216:219], v[64:67], v[128:131]
    ds_read_b64_tr_b16 v[212:213], v179 offset:4096
    v_mfma_f32_16x16x32_bf16 v[132:135], v[216:219], v[68:71], v[132:135]
    ds_read_b64_tr_b16 v[214:215], v179 offset:4608
    v_mfma_f32_16x16x32_bf16 v[136:139], v[220:223], v[64:67], v[136:139]
    v_add_u32 v176, s91, v176
    ds_read_b64_tr_b16 v[216:217], v176 offset:0
    v_mfma_f32_16x16x32_bf16 v[140:143], v[220:223], v[68:71], v[140:143]
    ds_read_b64_tr_b16 v[218:219], v176 offset:512
    s_waitcnt vmcnt(4) lgkmcnt(6)
    v_mfma_f32_16x16x32_bf16 v[160:163], v[224:227], v[72:75], v[160:163]
    v_add_u32 v177, s91, v177
    ds_read_b64_tr_b16 v[220:221], v177 offset:0
    v_mfma_f32_16x16x32_bf16 v[164:167], v[224:227], v[76:79], v[164:167]
    ds_read_b64_tr_b16 v[222:223], v177 offset:512
    v_mfma_f32_16x16x32_bf16 v[168:171], v[228:231], v[72:75], v[168:171]
    ds_read_b64_tr_b16 v[224:225], v176 offset:4096
    v_mfma_f32_16x16x32_bf16 v[172:175], v[228:231], v[76:79], v[172:175]
    ds_read_b64_tr_b16 v[226:227], v176 offset:4608
    s_waitcnt lgkmcnt(6)
    v_mfma_f32_16x16x32_bf16 v[128:131], v[208:211], v[72:75], v[128:131]
    ds_read_b64_tr_b16 v[228:229], v177 offset:4096
    v_mfma_f32_16x16x32_bf16 v[132:135], v[208:211], v[76:79], v[132:135]
    ds_read_b64_tr_b16 v[230:231], v177 offset:4608
    v_mfma_f32_16x16x32_bf16 v[136:139], v[212:215], v[72:75], v[136:139]
    v_add_u32 v178, s91, v178
    ds_read_b64_tr_b16 v[208:209], v178 offset:0
    v_mfma_f32_16x16x32_bf16 v[140:143], v[212:215], v[76:79], v[140:143]
    ds_read_b64_tr_b16 v[210:211], v178 offset:512
    s_waitcnt vmcnt(2) lgkmcnt(6)
    v_mfma_f32_16x16x32_bf16 v[160:163], v[216:219], v[80:83], v[160:163]
    v_add_u32 v179, s91, v179
    ds_read_b64_tr_b16 v[212:213], v179 offset:0
    v_mfma_f32_16x16x32_bf16 v[164:167], v[216:219], v[84:87], v[164:167]
    ds_read_b64_tr_b16 v[214:215], v179 offset:512
    v_mfma_f32_16x16x32_bf16 v[168:171], v[220:223], v[80:83], v[168:171]
    ds_read_b64_tr_b16 v[216:217], v178 offset:4096
    v_mfma_f32_16x16x32_bf16 v[172:175], v[220:223], v[84:87], v[172:175]
    ds_read_b64_tr_b16 v[218:219], v178 offset:4608
    s_waitcnt vmcnt(0) lgkmcnt(6)
    v_mfma_f32_16x16x32_bf16 v[160:163], v[224:227], v[88:91], v[160:163]
    ds_read_b64_tr_b16 v[220:221], v179 offset:4096
    v_mfma_f32_16x16x32_bf16 v[164:167], v[224:227], v[92:95], v[164:167]
    ds_read_b64_tr_b16 v[222:223], v179 offset:4608
    v_mfma_f32_16x16x32_bf16 v[168:171], v[228:231], v[88:91], v[168:171]
    v_mfma_f32_16x16x32_bf16 v[172:175], v[228:231], v[92:95], v[172:175]
    s_waitcnt lgkmcnt(4)
    v_mfma_f32_16x16x32_bf16 v[128:131], v[208:211], v[80:83], v[128:131]
    v_mfma_f32_16x16x32_bf16 v[132:135], v[208:211], v[84:87], v[132:135]
    v_mfma_f32_16x16x32_bf16 v[136:139], v[212:215], v[80:83], v[136:139]
    v_mfma_f32_16x16x32_bf16 v[140:143], v[212:215], v[84:87], v[140:143]
    s_nop 1
    ds_write_b128 v250, v[160:163] offset:0
    s_nop 0
    ds_write_b128 v250, v[164:167] offset:1024
    s_waitcnt lgkmcnt(2)
    v_mfma_f32_16x16x32_bf16 v[128:131], v[216:219], v[88:91], v[128:131]
    v_mfma_f32_16x16x32_bf16 v[132:135], v[216:219], v[92:95], v[132:135]
    ds_write_b128 v250, v[168:171] offset:2048
    ds_write_b128 v250, v[172:175] offset:3072
    v_mfma_f32_16x16x32_bf16 v[136:139], v[220:223], v[88:91], v[136:139]
    v_mfma_f32_16x16x32_bf16 v[140:143], v[220:223], v[92:95], v[140:143]
    s_waitcnt lgkmcnt(0)
    s_barrier
    ds_read_b128 v[144:147], v251 offset:0
    ds_read_b128 v[148:151], v251 offset:1024
    ds_read_b128 v[152:155], v251 offset:2048
    ds_read_b128 v[156:159], v251 offset:3072
    s_waitcnt lgkmcnt(3)
    v_add_f32 v144, v144, v128
    v_add_f32 v145, v145, v129
    v_add_f32 v146, v146, v130
    v_add_f32 v147, v147, v131
    s_waitcnt lgkmcnt(2)
    v_add_f32 v148, v148, v132
    v_add_f32 v149, v149, v133
    v_add_f32 v150, v150, v134
    v_add_f32 v151, v151, v135
    v_cvt_pk_bf16_f32 v232, v144, v145
    v_cvt_pk_bf16_f32 v233, v146, v147
    v_cvt_pk_bf16_f32 v234, v148, v149
    v_cvt_pk_bf16_f32 v235, v150, v151
    s_nop 0
    v_permlane16_swap_b32 v232, v234
    v_permlane16_swap_b32 v233, v235
    s_waitcnt lgkmcnt(1)
    v_add_f32 v152, v152, v136
    v_add_f32 v153, v153, v137
    v_add_f32 v154, v154, v138
    v_add_f32 v155, v155, v139
    s_waitcnt lgkmcnt(0)
    v_add_f32 v156, v156, v140
    v_add_f32 v157, v157, v141
    v_add_f32 v158, v158, v142
    v_add_f32 v159, v159, v143
    v_cvt_pk_bf16_f32 v236, v152, v153
    v_cvt_pk_bf16_f32 v237, v154, v155
    v_cvt_pk_bf16_f32 v238, v156, v157
    v_cvt_pk_bf16_f32 v239, v158, v159
    s_nop 0
    v_permlane16_swap_b32 v236, v238
    v_permlane16_swap_b32 v237, v239
    s_add_u32 s94, s95, 16384
    v_permlane16_swap_b32 v232, v236
    v_permlane16_swap_b32 v233, v237
    v_permlane16_swap_b32 v234, v238
    v_permlane16_swap_b32 v235, v239
    buffer_store_dwordx4 v[232:235], v249, s[44:47], s95 offen sc1
    buffer_store_dwordx4 v[236:239], v249, s[44:47], s94 offen sc1
    s_endpgm
.p2align 6
L_Bs:
    v_and_b32 v235, 63, v0
    s_waitcnt lgkmcnt(0)
    s_lshl_b32 s33, s21, 12
    v_lshlrev_b32 v245, 4, v235
    s_lshr_b32 s23, s21, 1
    s_and_b32 s22, s21, 1
    s_add_u32 s34, s34, s14
    s_sub_u32 s32, s34, 7
    s_min_u32 s34, s34, s32
    s_add_u32 s56, s30, 8388608
    s_addc_u32 s57, s31, 0
    s_mov_b32 s58, 114816
    s_mov_b32 s59, 0x20000
    v_lshlrev_b32 v180, 20, v235
    s_mov_b32 s74, s28
    s_mov_b32 s75, s29
    s_cmp_eq_u32 s2, 224
    s_cselect_b32 s32, s21, 0
    s_cmp_eq_u32 s32, 1
    s_cbranch_scc0 L_notag
    s_mov_b32 s88, s28
    s_mov_b32 s89, s29
    s_mov_b32 s90, 256
    s_mov_b32 s91, 0x20000
    s_mov_b32 s32, 114688
    buffer_load_dword v196, v180, s[56:59], s32 offen sc1
    v_mov_b32 v197, 1
    s_waitcnt vmcnt(0)
    v_add_u32 v196, 1, v196
    buffer_store_dwordx2 v[196:197], v180, s[88:91], 0 offen sc1
    buffer_store_dword v196, v180, s[56:59], s32 offen sc1
L_notag:
    s_barrier
    s_mov_b32 s48, s10
    s_mov_b32 s49, s11
    s_mov_b32 s50, 1835008
    s_mov_b32 s51, 0x20000
    v_bfe_u32 v234, v235, 4, 1
    v_lshlrev_b32 v234, 2, v234
    v_xor_b32 v234, v234, v235
    v_and_b32 v234, 7, v234
    v_lshrrev_b32 v232, 3, v235
    v_lshlrev_b32 v232, 10, v232
    v_lshl_add_u32 v176, v234, 4, v232
    v_xor_b32 v177, 32, v176
    v_add_u32 v177, 7168, v177
    v_add_u32 v178, 14336, v176
    v_add_u32 v179, 14336, v177
    v_and_b32 v232, 15, v235
    s_lshl_b32 s32, s22, 1
    s_xor_b32 s32, s32, 2
    v_subrev_u32 v233, 10, v232
    v_xor_b32 v233, s32, v233
    v_add_u32 v233, 10, v233
    v_cmp_le_u32 vcc, 26, v235
    s_nop 1
    v_cndmask_b32 v232, v232, v233, vcc
    v_lshl_add_u32 v232, v232, 1, s23
    v_mul_u32_u24 v233, 37, v232
    v_lshrrev_b32 v233, 8, v233
    v_mul_u32_u24 v234, 7, v233
    v_sub_u32 v234, v232, v234
    v_add_u32 v234, s34, v234
    v_subrev_u32 v236, 7, v234
    v_min_u32 v236, v234, v236
    v_mul_u32_u24 v237, 86, v234
    v_lshrrev_b32 v237, 8, v237
    v_mul_u32_u24 v237, 3, v237
    v_sub_u32 v237, v234, v237
    v_lshl_add_u32 v237, v237, 1, 1
    v_cmp_le_u32 vcc, 21, v232
    v_and_b32 v234, 3, v234
    v_lshlrev_b32 v234, 1, v234
    v_cndmask_b32 v236, v236, v237, vcc
    v_cmp_le_u32 vcc, 24, v232
    v_sub_u32 v233, s35, v233
    v_and_b32 v233, 3, v233
    v_cndmask_b32 v236, v236, v234, vcc
    v_mad_u32_u24 v232, v233, 7, v236
    s_lshl_b32 s95, s19, 7
    s_lshl_b32 s32, s22, 15
    s_add_u32 s32, s32, s95
    v_lshl_add_u32 v233, v232, 16, s32
    s_mul_i32 s32, s18, 3584
    s_lshl4_add_u32 s32, s22, s32
    v_lshl_add_u32 v183, v232, 7, s32
    v_readlane_b32 s60, v233, 0
    v_readlane_b32 s61, v233, 1
    v_readlane_b32 s62, v233, 2
    v_readlane_b32 s63, v233, 3
    v_readlane_b32 s64, v233, 4
    v_readlane_b32 s65, v233, 5
    v_readlane_b32 s66, v233, 6
    v_readlane_b32 s67, v233, 7
    v_readlane_b32 s68, v233, 8
    v_readlane_b32 s69, v233, 9
    v_readlane_b32 s70, v233, 10
    v_readlane_b32 s71, v233, 11
    v_readlane_b32 s72, v233, 12
    v_readlane_b32 s73, v233, 13
    s_mov_b32 s52, s30
    s_mov_b32 s53, s31
    s_mov_b32 s54, 7340032
    s_mov_b32 s55, 0x20000
    s_barrier
    s_add_u32 m0, s33, 49152
    s_nop 0
    buffer_load_dwordx4 v176, s[48:51], s60 offen offset:0 lds
    buffer_load_dwordx4 v177, s[48:51], s60 offen offset:1024 lds
    buffer_load_dwordx4 v178, s[48:51], s60 offen offset:2048 lds
    buffer_load_dwordx4 v179, s[48:51], s60 offen offset:3072 lds
    s_add_u32 m0, s33, 65536
    s_nop 0
    buffer_load_dwordx4 v176, s[48:51], s61 offen offset:0 lds
    buffer_load_dwordx4 v177, s[48:51], s61 offen offset:1024 lds
    buffer_load_dwordx4 v178, s[48:51], s61 offen offset:2048 lds
    buffer_load_dwordx4 v179, s[48:51], s61 offen offset:3072 lds
    s_add_u32 m0, s33, 81920
    s_nop 0
    buffer_load_dwordx4 v176, s[48:51], s62 offen offset:0 lds
    buffer_load_dwordx4 v177, s[48:51], s62 offen offset:1024 lds
    buffer_load_dwordx4 v178, s[48:51], s62 offen offset:2048 lds
    buffer_load_dwordx4 v179, s[48:51], s62 offen offset:3072 lds
    s_add_u32 m0, s33, 98304
    s_nop 0
    buffer_load_dwordx4 v176, s[48:51], s63 offen offset:0 lds
    buffer_load_dwordx4 v177, s[48:51], s63 offen offset:1024 lds
    buffer_load_dwordx4 v178, s[48:51], s63 offen offset:2048 lds
    buffer_load_dwordx4 v179, s[48:51], s63 offen offset:3072 lds
    s_add_u32 m0, s33, 131072
    s_nop 0
    buffer_load_dwordx4 v176, s[48:51], s64 offen offset:0 lds
    buffer_load_dwordx4 v177, s[48:51], s64 offen offset:1024 lds
    buffer_load_dwordx4 v178, s[48:51], s64 offen offset:2048 lds
    buffer_load_dwordx4 v179, s[48:51], s64 offen offset:3072 lds
    s_add_u32 m0, s33, 114688
    s_nop 0
    buffer_load_dwordx4 v176, s[48:51], s65 offen offset:0 lds
    buffer_load_dwordx4 v177, s[48:51], s65 offen offset:1024 lds
    buffer_load_dwordx4 v178, s[48:51], s65 offen offset:2048 lds
    buffer_load_dwordx4 v179, s[48:51], s65 offen offset:3072 lds
    s_add_u32 m0, s33, 147456
    s_nop 0
    buffer_load_dwordx4 v176, s[48:51], s66 offen offset:0 lds
    buffer_load_dwordx4 v177, s[48:51], s66 offen offset:1024 lds
    buffer_load_dwordx4 v178, s[48:51], s66 offen offset:2048 lds
    buffer_load_dwordx4 v179, s[48:51], s66 offen offset:3072 lds
    s_add_u32 m0, s33, 16384
    s_nop 0
    buffer_load_dwordx4 v176, s[48:51], s67 offen offset:0 lds
    buffer_load_dwordx4 v177, s[48:51], s67 offen offset:1024 lds
    buffer_load_dwordx4 v178, s[48:51], s67 offen offset:2048 lds
    buffer_load_dwordx4 v179, s[48:51], s67 offen offset:3072 lds
    s_add_u32 m0, s33, 32768
    s_nop 0
    buffer_load_dwordx4 v176, s[48:51], s68 offen offset:0 lds
    buffer_load_dwordx4 v177, s[48:51], s68 offen offset:1024 lds
    buffer_load_dwordx4 v178, s[48:51], s68 offen offset:2048 lds
    buffer_load_dwordx4 v179, s[48:51], s68 offen offset:3072 lds
    s_add_u32 m0, s33, 0
    s_nop 0
    buffer_load_dwordx4 v176, s[48:51], s69 offen offset:0 lds
    buffer_load_dwordx4 v177, s[48:51], s69 offen offset:1024 lds
    buffer_load_dwordx4 v178, s[48:51], s69 offen offset:2048 lds
    buffer_load_dwordx4 v179, s[48:51], s69 offen offset:3072 lds
    s_setprio 0
    s_load_dwordx2 s[14:15], s[74:75], 0
    s_load_dword s4, s[56:57], 114752
    s_mov_b32 s97, 0
    s_waitcnt lgkmcnt(0)
L_tagbs0:
    s_cmp_lg_u32 s15, 0
    s_cbranch_scc1 L_tagokbs0
    s_add_u32 s97, s97, 1
    s_cmp_ge_u32 s97, 0x100000
    s_cbranch_scc1 L_tagokbs0
    s_sleep 2
    v_mov_b32 v198, 0
    global_load_dwordx2 v[196:197], v198, s[74:75] sc1
    s_waitcnt vmcnt(0)
    v_readfirstlane_b32 s14, v196
    v_readfirstlane_b32 s15, v197
    s_nop 1
    s_branch L_tagbs0
L_tagokbs0:
    v_mov_b32 v182, s14
    s_mov_b32 s15, s14
    s_add_u32 s88, s22, 16
    s_min_u32 s88, s88, 18
    s_add_u32 s89, s22, 18
    s_min_u32 s89, s89, 18
    v_readlane_b32 s88, v183, s88
    v_readlane_b32 s89, v183, s89
    s_nop 3
    s_load_dwordx4 s[4:7], s[56:57], s88 glc
    s_load_dwordx4 s[8:11], s[56:57], s89 glc
    s_mov_b32 s96, 0
L_pollbs00:
    s_waitcnt lgkmcnt(0)
    s_xor_b64 s[4:5], s[4:5], s[14:15]
    s_xor_b64 s[6:7], s[6:7], s[14:15]
    s_xor_b64 s[8:9], s[8:9], s[14:15]
    s_xor_b64 s[10:11], s[10:11], s[14:15]
    s_or_b64 s[4:5], s[4:5], s[6:7]
    s_or_b64 s[4:5], s[4:5], s[8:9]
    s_or_b64 s[4:5], s[4:5], s[10:11]
    s_cbranch_scc0 L_okbs00
    s_add_u32 s96, s96, 1
    s_cmp_ge_u32 s96, 0x100000
    s_cbranch_scc1 L_okbs00
    s_sleep 8
    s_and_b32 s4, s96, 63
    s_cbranch_scc1 L_spbs00
    s_mov_b64 exec, 0x70000
    buffer_load_dwordx4 v[196:199], v183, s[56:59], 0 offen sc1
    s_mov_b64 exec, -1
    s_waitcnt vmcnt(0)
    v_cmp_eq_u64 vcc, s[14:15], v[196:197]
    v_cmp_eq_u64_e64 s[4:5], s[14:15], v[198:199]
    s_nop 1
    s_and_b32 s4, s4, vcc_lo
    s_andn2_b32 s4, 0x70000, s4
    s_cbranch_scc0 L_okbs00
L_spbs00:
    s_load_dwordx4 s[4:7], s[56:57], s88 glc
    s_load_dwordx4 s[8:11], s[56:57], s89 glc
    s_branch L_pollbs00
L_okbs00:
    s_barrier
    s_add_u32 s88, s22, 19
    s_min_u32 s88, s88, 22
    s_add_u32 s89, s22, 21
    s_min_u32 s89, s89, 22
    v_readlane_b32 s88, v183, s88
    v_readlane_b32 s89, v183, s89
    s_nop 3
    s_load_dwordx4 s[4:7], s[56:57], s88 glc
    s_load_dwordx4 s[8:11], s[56:57], s89 glc
    s_mov_b32 s96, 0
L_pollbs01:
    s_waitcnt lgkmcnt(0)
    s_xor_b64 s[4:5], s[4:5], s[14:15]
    s_xor_b64 s[6:7], s[6:7], s[14:15]
    s_xor_b64 s[8:9], s[8:9], s[14:15]
    s_xor_b64 s[10:11], s[10:11], s[14:15]
    s_or_b64 s[4:5], s[4:5], s[6:7]
    s_or_b64 s[4:5], s[4:5], s[8:9]
    s_or_b64 s[4:5], s[4:5], s[10:11]
    s_cbranch_scc0 L_okbs01
    s_add_u32 s96, s96, 1
    s_cmp_ge_u32 s96, 0x100000
    s_cbranch_scc1 L_okbs01
    s_sleep 2
    s_and_b32 s4, s96, 63
    s_cbranch_scc1 L_spbs01
    s_mov_b64 exec, 0x780000
    buffer_load_dwordx4 v[196:199], v183, s[56:59], 0 offen sc1
    s_mov_b64 exec, -1
    s_waitcnt vmcnt(0)
    v_cmp_eq_u64 vcc, s[14:15], v[196:197]
    v_cmp_eq_u64_e64 s[4:5], s[14:15], v[198:199]
    s_nop 1
    s_and_b32 s4, s4, vcc_lo
    s_andn2_b32 s4, 0x780000, s4
    s_cbranch_scc0 L_okbs01
L_spbs01:
    s_load_dwordx4 s[4:7], s[56:57], s88 glc
    s_load_dwordx4 s[8:11], s[56:57], s89 glc
    s_branch L_pollbs01
L_okbs01:
    s_barrier
    s_waitcnt vmcnt(24)
    s_barrier
    s_waitcnt vmcnt(16)
    s_barrier
    s_add_u32 m0, s33, 49152
    s_nop 0
    buffer_load_dwordx4 v176, s[48:51], s70 offen offset:0 lds
    buffer_load_dwordx4 v177, s[48:51], s70 offen offset:1024 lds
    buffer_load_dwordx4 v178, s[48:51], s70 offen offset:2048 lds
    buffer_load_dwordx4 v179, s[48:51], s70 offen offset:3072 lds
    s_add_u32 s88, s22, 23
    s_min_u32 s88, s88, 25
    s_add_u32 s89, s22, 25
    s_min_u32 s89, s89, 25
    v_readlane_b32 s88, v183, s88
    v_readlane_b32 s89, v183, s89
    s_nop 3
    s_load_dwordx4 s[4:7], s[56:57], s88 glc
    s_load_dwordx4 s[8:11], s[56:57], s89 glc
    s_mov_b32 s96, 0
L_pollbs02:
    s_waitcnt lgkmcnt(0)
    s_xor_b64 s[4:5], s[4:5], s[14:15]
    s_xor_b64 s[6:7], s[6:7], s[14:15]
    s_xor_b64 s[8:9], s[8:9], s[14:15]
    s_xor_b64 s[10:11], s[10:11], s[14:15]
    s_or_b64 s[4:5], s[4:5], s[6:7]
    s_or_b64 s[4:5], s[4:5], s[8:9]
    s_or_b64 s[4:5], s[4:5], s[10:11]
    s_cbranch_scc0 L_okbs02
    s_add_u32 s96, s96, 1
    s_cmp_ge_u32 s96, 0x100000
    s_cbranch_scc1 L_okbs02
    s_sleep 2
    s_and_b32 s4, s96, 63
    s_cbranch_scc1 L_spbs02
    s_mov_b64 exec, 0x3800000
    buffer_load_dwordx4 v[196:199], v183, s[56:59], 0 offen sc1
    s_mov_b64 exec, -1
    s_waitcnt vmcnt(0)
    v_cmp_eq_u64 vcc, s[14:15], v[196:197]
    v_cmp_eq_u64_e64 s[4:5], s[14:15], v[198:199]
    s_nop 1
    s_and_b32 s4, s4, vcc_lo
    s_andn2_b32 s4, 0x3800000, s4
    s_cbranch_scc0 L_okbs02
L_spbs02:
    s_load_dwordx4 s[4:7], s[56:57], s88 glc
    s_load_dwordx4 s[8:11], s[56:57], s89 glc
    s_branch L_pollbs02
L_okbs02:
    s_waitcnt vmcnt(12)
    s_barrier
    s_add_u32 m0, s33, 65536
    s_nop 0
    buffer_load_dwordx4 v176, s[48:51], s71 offen offset:0 lds
    buffer_load_dwordx4 v177, s[48:51], s71 offen offset:1024 lds
    buffer_load_dwordx4 v178, s[48:51], s71 offen offset:2048 lds
    buffer_load_dwordx4 v179, s[48:51], s71 offen offset:3072 lds
    s_add_u32 m0, s33, 81920
    s_nop 0
    buffer_load_dwordx4 v176, s[48:51], s72 offen offset:0 lds
    buffer_load_dwordx4 v177, s[48:51], s72 offen offset:1024 lds
    buffer_load_dwordx4 v178, s[48:51], s72 offen offset:2048 lds
    buffer_load_dwordx4 v179, s[48:51], s72 offen offset:3072 lds
    s_waitcnt vmcnt(12)
    s_barrier
    s_add_u32 m0, s33, 98304
    s_nop 0
    buffer_load_dwordx4 v176, s[48:51], s73 offen offset:0 lds
    buffer_load_dwordx4 v177, s[48:51], s73 offen offset:1024 lds
    buffer_load_dwordx4 v178, s[48:51], s73 offen offset:2048 lds
    buffer_load_dwordx4 v179, s[48:51], s73 offen offset:3072 lds
    v_readlane_b32 s88, v183, 26
    v_readlane_b32 s89, v183, 27
    s_nop 3
    s_load_dwordx4 s[4:7], s[56:57], s88 glc
    s_load_dwordx4 s[8:11], s[56:57], s89 glc
    s_mov_b32 s96, 0
L_pollbs03:
    s_waitcnt lgkmcnt(0)
    s_xor_b64 s[4:5], s[4:5], s[14:15]
    s_xor_b64 s[6:7], s[6:7], s[14:15]
    s_xor_b64 s[8:9], s[8:9], s[14:15]
    s_xor_b64 s[10:11], s[10:11], s[14:15]
    s_or_b64 s[4:5], s[4:5], s[6:7]
    s_or_b64 s[4:5], s[4:5], s[8:9]
    s_or_b64 s[4:5], s[4:5], s[10:11]
    s_cbranch_scc0 L_okbs03
    s_add_u32 s96, s96, 1
    s_cmp_ge_u32 s96, 0x100000
    s_cbranch_scc1 L_okbs03
    s_sleep 2
    s_and_b32 s4, s96, 63
    s_cbranch_scc1 L_spbs03
    s_mov_b64 exec, 0xc000000
    buffer_load_dwordx4 v[196:199], v183, s[56:59], 0 offen sc1
    s_mov_b64 exec, -1
    s_waitcnt vmcnt(0)
    v_cmp_eq_u64 vcc, s[14:15], v[196:197]
    v_cmp_eq_u64_e64 s[4:5], s[14:15], v[198:199]
    s_nop 1
    s_and_b32 s4, s4, vcc_lo
    s_andn2_b32 s4, 0xc000000, s4
    s_cbranch_scc0 L_okbs03
L_spbs03:
    s_load_dwordx4 s[4:7], s[56:57], s88 glc
    s_load_dwordx4 s[8:11], s[56:57], s89 glc
    s_branch L_pollbs03
L_okbs03:
    s_waitcnt vmcnt(0)
    s_barrier
    v_readlane_b32 s88, v183, 28
    v_readlane_b32 s89, v183, 29
    s_nop 3
    s_load_dwordx4 s[4:7], s[56:57], s88 glc
    s_load_dwordx4 s[8:11], s[56:57], s89 glc
    s_mov_b32 s96, 0
L_pollbs04:
    s_waitcnt lgkmcnt(0)
    s_xor_b64 s[4:5], s[4:5], s[14:15]
    s_xor_b64 s[6:7], s[6:7], s[14:15]
    s_xor_b64 s[8:9], s[8:9], s[14:15]
    s_xor_b64 s[10:11], s[10:11], s[14:15]
    s_or_b64 s[4:5], s[4:5], s[6:7]
    s_or_b64 s[4:5], s[4:5], s[8:9]
    s_or_b64 s[4:5], s[4:5], s[10:11]
    s_cbranch_scc0 L_okbs04
    s_add_u32 s96, s96, 1
    s_cmp_ge_u32 s96, 0x100000
    s_cbranch_scc1 L_okbs04
    s_sleep 2
    s_and_b32 s4, s96, 63
    s_cbranch_scc1 L_spbs04
    s_mov_b64 exec, 0x30000000
    buffer_load_dwordx4 v[196:199], v183, s[56:59], 0 offen sc1
    s_mov_b64 exec, -1
    s_waitcnt vmcnt(0)
    v_cmp_eq_u64 vcc, s[14:15], v[196:197]
    v_cmp_eq_u64_e64 s[4:5], s[14:15], v[198:199]
    s_nop 1
    s_and_b32 s4, s4, vcc_lo
    s_andn2_b32 s4, 0x30000000, s4
    s_cbranch_scc0 L_okbs04
L_spbs04:
    s_load_dwordx4 s[4:7], s[56:57], s88 glc
    s_load_dwordx4 s[8:11], s[56:57], s89 glc
    s_branch L_pollbs04
L_okbs04:
    s_barrier
    s_endpgm
L_end:
    s_endpgm
L_codeend:
.section .rodata,"a"
.p2align 6
.amdhsa_kernel standalone__geglu_ffn__prompt_kernel
  .amdhsa_next_free_vgpr 256
  .amdhsa_next_free_sgpr 102
  .amdhsa_accum_offset 256
  .amdhsa_group_segment_fixed_size 0
  .amdhsa_kernarg_size 56
  .amdhsa_user_sgpr_count 2
  .amdhsa_user_sgpr_kernarg_segment_ptr 1
  .amdhsa_system_sgpr_workgroup_id_x 1
.end_amdhsa_kernel
```
